```python
import torch

def _softmax(x, axis=-1):
    return torch.softmax(x, dim=axis)
def _gelu(x):
    return torch.nn.functional.gelu(x, approximate="tanh")
def _silu(x):
    return torch.nn.functional.silu(x)
def _sigmoid(x):
    return torch.sigmoid(x)
def _layernorm(x, axis=-1, eps=1e-5):
    m = x.mean(dim=axis, keepdim=True)
    v = x.var(dim=axis, keepdim=True, unbiased=False)
    return (x - m) / torch.sqrt(v + eps)
def _scatter_add(tgt, idx, src, axis=0):
    return tgt.clone().index_add_(axis, idx, src)
def _segment_sum(src, seg, n):
    out = torch.zeros((n,) + src.shape[1:], dtype=src.dtype)
    return out.index_add_(0, seg, src)
def _pad(x, pw):
    flat = tuple(v for pair in reversed(pw) for v in pair)
    return torch.nn.functional.pad(x, flat)

kernel_name = 'standalone__batchnorm__prompt'

def setup_inputs():

    _w = (lambda a: (lambda t: t.to(torch.bfloat16) if t.is_floating_point() else t)(torch.as_tensor(a)))
    B, S, C = 4, 2048, 448
    K = 3
    return {
        "x": _w((lambda *s: torch.randn(*s, dtype=torch.bfloat16) * 0.05)(B, S, C)),
        "w": _w((lambda *s: torch.randn(*s, dtype=torch.bfloat16) * 0.05)(K, C, C) * (1.0 / (K * C) ** 0.5)),
        "mean": _w((lambda *s: torch.randn(*s, dtype=torch.bfloat16) * 0.05)(C) * 0.1),
        "var": _w(torch.abs((lambda *s: torch.randn(*s, dtype=torch.bfloat16) * 0.05)(C)) + 0.5),
        "g": _w((lambda *s: torch.randn(*s, dtype=torch.bfloat16) * 0.05)(C) + 1.0),
        "b": _w((lambda *s: torch.randn(*s, dtype=torch.bfloat16) * 0.05)(C) * 0.1),
    }

def reference(x, w, mean, var, g, b):
    K = 3
    P = K // 2
    S = x.shape[1]
    xp = _pad(x, ((0, 0), (P, P), (0, 0)))
    y = sum(torch.einsum('bsc,cd->bsd', xp[:, k:k + S, :], w[k]) for k in range(K))
    inv_std = 1.0 / torch.sqrt(var + 1e-5)
    y = (y - mean) * (g * inv_std) + b
    return _silu(y)
```

```asm
; @launch grid=(256,1,1) block=(512,1,1) lds=163808
.amdgcn_target "amdgcn-amd-amdhsa--gfx950"
.text
.globl standalone__batchnorm__prompt_kernel
.p2align 12
.p2align 8
.type standalone__batchnorm__prompt_kernel,@function
standalone__batchnorm__prompt_kernel:
    s_load_dwordx2 s[24:25], s[0:1], 0
    s_load_dwordx2 s[28:29], s[0:1], 8
    s_load_dwordx8 s[8:15], s[0:1], 16
    s_load_dwordx2 s[32:33], s[0:1], 48
    s_cmp_ge_u32 s2, 256
    s_cbranch_scc1 L_end
    v_lshrrev_b32 v1, 6, v0
    v_and_b32 v0, 63, v0
    v_readfirstlane_b32 s3, v1
    s_mov_b32 s26, 7340032
    s_mov_b32 s27, 0x20000
    s_mov_b32 s30, 1204224
    s_mov_b32 s31, s27
    s_mov_b64 s[34:35], s[26:27]
    s_and_b32 s22, s2, 7
    s_lshr_b32 s23, s2, 3
    s_cmp_eq_u32 s22, 7
    s_cselect_b32 s53, 3, s22
    s_lshl_b32 s54, s53, 7
    s_lshl_b32 s22, s22, 2
    s_cmp_lt_u32 s23, 4
    s_cbranch_scc1 L_pref
    s_sub_u32 s23, s23, 4
    s_mul_i32 s36, s23, 37
    s_lshr_b32 s47, s36, 8
    s_mul_i32 s37, s47, 7
    s_sub_u32 s37, s23, s37
    s_add_u32 s36, s47, s22
    s_mul_i32 s38, s36, 229376
    s_lshl_b32 s39, s37, 7
    s_and_b32 s40, s3, 3
    s_cmp_lt_u32 s3, 4
    s_cbranch_scc1 L_cpre
L_loader:
    s_mul_i32 s55, s53, 57344
    s_mov_b32 s41, 401408
    v_lshrrev_b32 v1, 3, v0
    v_and_b32 v3, 7, v0
    v_mul_u32_u24 v5, 896, v1
    v_and_b32 v4, 2, v1
    s_and_b32 s42, s40, 1
    s_lshl_b32 s42, s42, 2
    v_xor_b32 v4, s42, v4
    v_xor_b32 v4, v4, v3
    v_lshl_add_u32 v4, v4, 4, v5
    s_mul_i32 s43, s40, 7168
    s_add_u32 s43, s43, s39
    v_add_u32 v11, s43, v4
    s_lshl_b32 s51, s40, 10
    s_mul_i32 s59, s40, 57344
    s_add_u32 s59, s59, s38
    v_and_b32 v4, 6, v1
    v_xor_b32 v4, v4, v3
    v_lshlrev_b32 v4, 4, v4
    v_lshl_add_u32 v4, v5, 3, v4
    v_add_u32 v9, s59, v4
    s_waitcnt lgkmcnt(0)
    s_mov_b32 m0, s51
    s_mov_b32 s58, s55
    buffer_load_dwordx4 v11, s[28:31], s58 offen  lds
    s_addk_i32 m0, 4096
    s_add_u32 s58, s58, s41
    buffer_load_dwordx4 v11, s[28:31], s58 offen  lds
    s_addk_i32 m0, 4096
    s_add_u32 s58, s58, s41
    buffer_load_dwordx4 v11, s[28:31], s58 offen  lds
    s_addk_i32 s55, 28672
    s_add_u32 m0, s51, 61568
    s_add_u32 s52, s54, 6272
    buffer_load_dwordx4 v9, s[24:27], s52 offen  lds
    s_addk_i32 m0, 28672
    s_addk_i32 s52, -6272
    buffer_load_dwordx4 v9, s[24:27], s52 offen  lds
    s_addk_i32 m0, -4096
    s_addk_i32 s52, 896
    buffer_load_dwordx4 v9, s[24:27], s52 offen  lds
    v_add_u32 v4, s42, v0
    s_and_b32 s43, s36, 7
    s_cmp_lt_u32 s40, 2
    s_cselect_b32 s46, 0, 7
    s_cselect_b32 s48, 0, 230272
    s_cselect_b32 s49, 0, 33952
    s_cselect_b32 s56, 0, 32896
    s_cselect_b32 s57, 0x60, 0
    s_add_u32 s48, s48, s38
    s_sub_u32 s48, s48, 896
    s_cmp_eq_u32 s43, s46
    s_cselect_b32 s48, 0x80000000, s48
    v_lshlrev_b32 v4, 4, v4
    v_add_u32 v10, s48, v4
    v_xor_b32 v7, s57, v10
    s_lshl_b32 s42, s42, 4
    s_add_u32 s42, s42, 61440
    s_add_u32 s49, s49, s42
    s_add_u32 s56, s56, s42
    s_mov_b32 m0, s56
    s_mov_b64 exec, 15
    buffer_load_dwordx4 v7, s[24:27], s54 offen  lds
    s_mov_b64 exec, -1
    s_add_u32 m0, s51, 82048
    s_addk_i32 s52, 896
    buffer_load_dwordx4 v9, s[24:27], s52 offen  lds
    s_addk_i32 m0, -4096
    s_addk_i32 s52, 896
    buffer_load_dwordx4 v9, s[24:27], s52 offen  lds
    s_addk_i32 m0, -4096
    s_addk_i32 s52, 896
    buffer_load_dwordx4 v9, s[24:27], s52 offen  lds
    s_addk_i32 m0, -4096
    s_addk_i32 s52, 896
    buffer_load_dwordx4 v9, s[24:27], s52 offen  lds
    s_addk_i32 m0, -4096
    s_addk_i32 s52, 896
    buffer_load_dwordx4 v9, s[24:27], s52 offen  lds
    v_lshl_add_u32 v4, v3, 4, v5
    v_add_u32 v8, s59, v4
    s_mul_i32 s50, s40, 8448
    s_add_u32 s50, s50, 61600
    v_lshlrev_b32 v6, 1, v0
    v_add_u32 v6, s39, v6
    s_addk_i32 s54, 128
    s_cmpk_eq_u32 s54, 896
    s_cselect_b32 s54, 0, s54
    s_branch L_loader2
L_cpre:
    v_mov_b32 v5, -1
    s_cmp_eq_u32 s40, 2
    s_cbranch_scc1 L_stub1
    s_cmp_eq_u32 s40, 3
    s_cbranch_scc1 L_stub2
    s_cmp_lg_u32 s40, 0
    s_cbranch_scc1 L_consumer
    v_mul_u32_u24 v20, 7, v0
    v_add_u32 v20, s37, v20
    v_min_u32 v20, 255, v20
    v_mul_u32_u24 v20, 896, v20
    v_add_u32 v23, s38, v20
    v_lshlrev_b32 v21, 2, v0
    v_add_u32 v21, s47, v21
    v_lshrrev_b32 v22, 6, v21
    v_and_b32 v21, 63, v21
    v_mul_u32_u24 v22, 448, v22
    v_add_u32 v21, v21, v22
    v_mul_u32_u24 v21, 896, v21
    v_add_u32 v22, s39, v21
    s_mul_i32 s55, s53, 57344
    s_waitcnt lgkmcnt(0)
    s_mov_b32 exec_lo, 0xff00ff00
    s_mov_b32 exec_hi, exec_lo
    buffer_load_dword v31, v22, s[28:31], s55 offen
    s_mov_b64 exec, -1
    s_branch L_consumer
L_pref:
    s_cmp_lg_u32 s3, 0
    s_cbranch_scc1 L_end
    s_add_u32 s36, s23, s22
    s_mul_i32 s38, s36, 229376
    v_mul_u32_u24 v1, 896, v0
    v_add_u32 v1, s38, v1
    v_add_u32 v4, 57344, v1
    v_add_u32 v5, 114688, v1
    v_add_u32 v6, 172032, v1
    s_getpc_b64 s[56:57]
L_pc:
    s_sub_u32 s56, s56, L_pc-standalone__batchnorm__prompt_kernel
    s_subb_u32 s57, s57, 0
    s_mul_i32 s42, s23, 5120
    v_min_u32 v2, 39, v0
    v_lshlrev_b32 v2, 7, v2
    v_add_u32 v2, s42, v2
    v_min_u32 v2, L_end-standalone__batchnorm__prompt_kernel, v2
    global_load_dword v3, v2, s[56:57]
    v_lshlrev_b32 v7, 7, v0
    s_mul_i32 s42, s23, 14336
    v_add_u32 v7, s42, v7
    v_min_u32 v8, 47, v0
    v_lshlrev_b32 v8, 7, v8
    s_add_u32 s42, s42, 8192
    v_add_u32 v8, s42, v8
    s_waitcnt lgkmcnt(0)
    s_mov_b32 exec_lo, 0x7c7c7c7c
    s_mov_b32 exec_hi, exec_lo
    buffer_load_dword v3, v1, s[24:27], s54 offen
    buffer_load_dword v3, v4, s[24:27], s54 offen
    buffer_load_dword v3, v5, s[24:27], s54 offen
    buffer_load_dword v3, v6, s[24:27], s54 offen
    s_mov_b64 exec, -1
    v_min_u32 v9, 6, v0
    v_lshlrev_b32 v9, 7, v9
    global_load_dword v3, v9, s[8:9]
    global_load_dword v3, v9, s[10:11]
    global_load_dword v3, v9, s[12:13]
    global_load_dword v3, v9, s[14:15]
    s_addk_i32 s54, 128
    s_cmpk_eq_u32 s54, 896
    s_cselect_b32 s54, 0, s54
    buffer_load_dword v3, v1, s[24:27], s54 offen
    buffer_load_dword v3, v4, s[24:27], s54 offen
    buffer_load_dword v3, v5, s[24:27], s54 offen
    buffer_load_dword v3, v6, s[24:27], s54 offen
    s_mul_i32 s55, s54, 448
    s_add_u32 s52, s55, 0
    buffer_load_dword v3, v7, s[28:31], s52 offen
    buffer_load_dword v3, v8, s[28:31], s52 offen
    s_add_u32 s52, s55, 401408
    buffer_load_dword v3, v7, s[28:31], s52 offen
    buffer_load_dword v3, v8, s[28:31], s52 offen
    s_add_u32 s52, s55, 802816
    buffer_load_dword v3, v7, s[28:31], s52 offen
    buffer_load_dword v3, v8, s[28:31], s52 offen
    s_addk_i32 s54, 128
    s_cmpk_eq_u32 s54, 896
    s_cselect_b32 s54, 0, s54
    buffer_load_dword v3, v1, s[24:27], s54 offen
    buffer_load_dword v3, v4, s[24:27], s54 offen
    buffer_load_dword v3, v5, s[24:27], s54 offen
    buffer_load_dword v3, v6, s[24:27], s54 offen
    s_addk_i32 s54, 128
    s_cmpk_eq_u32 s54, 896
    s_cselect_b32 s54, 0, s54
    buffer_load_dword v3, v1, s[24:27], s54 offen
    buffer_load_dword v3, v4, s[24:27], s54 offen
    buffer_load_dword v3, v5, s[24:27], s54 offen
    buffer_load_dword v3, v6, s[24:27], s54 offen
    s_addk_i32 s54, 128
    s_cmpk_eq_u32 s54, 896
    s_cselect_b32 s54, 0, s54
    buffer_load_dword v3, v1, s[24:27], s54 offen
    buffer_load_dword v3, v4, s[24:27], s54 offen
    buffer_load_dword v3, v5, s[24:27], s54 offen
    buffer_load_dword v3, v6, s[24:27], s54 offen
    s_addk_i32 s54, 128
    s_cmpk_eq_u32 s54, 896
    s_cselect_b32 s54, 0, s54
    buffer_load_dword v3, v1, s[24:27], s54 offen
    buffer_load_dword v3, v4, s[24:27], s54 offen
    buffer_load_dword v3, v5, s[24:27], s54 offen
    buffer_load_dword v3, v6, s[24:27], s54 offen
    s_addk_i32 s54, 128
    s_cmpk_eq_u32 s54, 896
    s_cselect_b32 s54, 0, s54
    buffer_load_dword v3, v1, s[24:27], s54 offen
    buffer_load_dword v3, v4, s[24:27], s54 offen
    buffer_load_dword v3, v5, s[24:27], s54 offen
    buffer_load_dword v3, v6, s[24:27], s54 offen
    s_endpgm
L_loader2:
    s_add_u32 m0, s51, 12288
    s_mov_b32 s58, s55
    buffer_load_dwordx4 v11, s[28:31], s58 offen  lds
    s_addk_i32 m0, 4096
    s_add_u32 s58, s58, s41
    buffer_load_dwordx4 v11, s[28:31], s58 offen  lds
    s_waitcnt vmcnt(7)
    s_barrier
    s_addk_i32 m0, 4096
    s_add_u32 s58, s58, s41
    buffer_load_dwordx4 v11, s[28:31], s58 offen  lds
    s_addk_i32 s55, 28672
    s_cmp_eq_u32 s55, s41
    s_cselect_b32 s55, 0, s55
    s_addk_i32 m0, 4096
    s_mov_b32 s58, s55
    buffer_load_dwordx4 v11, s[28:31], s58 offen  lds
    s_waitcnt vmcnt(7)
    s_barrier
    s_addk_i32 m0, 4096
    s_add_u32 s58, s58, s41
    buffer_load_dwordx4 v11, s[28:31], s58 offen  lds
    s_addk_i32 m0, 4096
    s_add_u32 s58, s58, s41
    buffer_load_dwordx4 v11, s[28:31], s58 offen  lds
    s_addk_i32 s55, 28672
    s_add_u32 m0, s50, 34080
    s_mov_b32 s52, s54
    buffer_load_dwordx4 v8, s[24:27], s52 offen  lds
    s_waitcnt vmcnt(7)
    s_barrier
    s_addk_i32 m0, 1056
    s_addk_i32 s52, 7168
    buffer_load_dwordx4 v8, s[24:27], s52 offen  lds
    s_addk_i32 m0, 1056
    s_addk_i32 s52, 7168
    buffer_load_dwordx4 v8, s[24:27], s52 offen  lds
    s_addk_i32 m0, 1056
    s_addk_i32 s52, 7168
    buffer_load_dwordx4 v8, s[24:27], s52 offen  lds
    s_addk_i32 m0, 1056
    s_addk_i32 s52, 7168
    buffer_load_dwordx4 v8, s[24:27], s52 offen  lds
    s_waitcnt vmcnt(8)
    s_barrier
    s_addk_i32 m0, 1056
    s_addk_i32 s52, 7168
    buffer_load_dwordx4 v8, s[24:27], s52 offen  lds
    s_addk_i32 m0, 1056
    s_addk_i32 s52, 7168
    buffer_load_dwordx4 v8, s[24:27], s52 offen  lds
    s_addk_i32 m0, 1056
    s_addk_i32 s52, 7168
    buffer_load_dwordx4 v8, s[24:27], s52 offen  lds
    s_add_u32 m0, s49, 34080
    s_mov_b64 exec, 15
    buffer_load_dwordx4 v10, s[24:27], s54 offen  lds
    s_mov_b64 exec, -1
    s_addk_i32 s54, 128
    s_cmpk_eq_u32 s54, 896
    s_cselect_b32 s54, 0, s54
    s_add_u32 m0, s51, 36864
    s_mov_b32 s58, s55
    buffer_load_dwordx4 v11, s[28:31], s58 offen  lds
    s_addk_i32 m0, 4096
    s_add_u32 s58, s58, s41
    buffer_load_dwordx4 v11, s[28:31], s58 offen  lds
    s_addk_i32 m0, 4096
    s_add_u32 s58, s58, s41
    buffer_load_dwordx4 v11, s[28:31], s58 offen  lds
    s_addk_i32 s55, 28672
    s_cmp_eq_u32 s55, s41
    s_cselect_b32 s55, 0, s55
    s_addk_i32 m0, 4096
    s_mov_b32 s58, s55
    buffer_load_dwordx4 v11, s[28:31], s58 offen  lds
    s_addk_i32 m0, 4096
    s_add_u32 s58, s58, s41
    buffer_load_dwordx4 v11, s[28:31], s58 offen  lds
    s_addk_i32 m0, 4096
    s_add_u32 s58, s58, s41
    buffer_load_dwordx4 v11, s[28:31], s58 offen  lds
    s_addk_i32 s55, 28672
    s_waitcnt vmcnt(6)
    s_barrier
    s_add_u32 m0, s50, 68160
    s_mov_b32 s52, s54
    buffer_load_dwordx4 v8, s[24:27], s52 offen  lds
    s_addk_i32 m0, 1056
    s_addk_i32 s52, 7168
    buffer_load_dwordx4 v8, s[24:27], s52 offen  lds
    s_addk_i32 m0, 1056
    s_addk_i32 s52, 7168
    buffer_load_dwordx4 v8, s[24:27], s52 offen  lds
    s_addk_i32 m0, 1056
    s_addk_i32 s52, 7168
    buffer_load_dwordx4 v8, s[24:27], s52 offen  lds
    s_addk_i32 m0, 1056
    s_addk_i32 s52, 7168
    buffer_load_dwordx4 v8, s[24:27], s52 offen  lds
    s_addk_i32 m0, 1056
    s_addk_i32 s52, 7168
    buffer_load_dwordx4 v8, s[24:27], s52 offen  lds
    s_addk_i32 m0, 1056
    s_addk_i32 s52, 7168
    buffer_load_dwordx4 v8, s[24:27], s52 offen  lds
    s_addk_i32 m0, 1056
    s_addk_i32 s52, 7168
    buffer_load_dwordx4 v8, s[24:27], s52 offen  lds
    s_add_u32 m0, s49, 68160
    s_mov_b64 exec, 15
    buffer_load_dwordx4 v10, s[24:27], s54 offen  lds
    s_mov_b64 exec, -1
    s_addk_i32 s54, 128
    s_cmpk_eq_u32 s54, 896
    s_cselect_b32 s54, 0, s54
    s_waitcnt vmcnt(12)
    s_barrier
    s_mov_b32 m0, s51
    s_mov_b32 s58, s55
    buffer_load_dwordx4 v11, s[28:31], s58 offen  lds
    s_addk_i32 m0, 4096
    s_add_u32 s58, s58, s41
    buffer_load_dwordx4 v11, s[28:31], s58 offen  lds
    s_addk_i32 m0, 4096
    s_add_u32 s58, s58, s41
    buffer_load_dwordx4 v11, s[28:31], s58 offen  lds
    s_addk_i32 s55, 28672
    s_cmp_eq_u32 s55, s41
    s_cselect_b32 s55, 0, s55
    s_addk_i32 m0, 4096
    s_mov_b32 s58, s55
    buffer_load_dwordx4 v11, s[28:31], s58 offen  lds
    s_addk_i32 m0, 4096
    s_add_u32 s58, s58, s41
    buffer_load_dwordx4 v11, s[28:31], s58 offen  lds
    s_addk_i32 m0, 4096
    s_add_u32 s58, s58, s41
    buffer_load_dwordx4 v11, s[28:31], s58 offen  lds
    s_addk_i32 s55, 28672
    s_mov_b32 m0, s50
    s_mov_b32 s52, s54
    buffer_load_dwordx4 v8, s[24:27], s52 offen  lds
    s_addk_i32 m0, 1056
    s_addk_i32 s52, 7168
    buffer_load_dwordx4 v8, s[24:27], s52 offen  lds
    s_addk_i32 m0, 1056
    s_addk_i32 s52, 7168
    buffer_load_dwordx4 v8, s[24:27], s52 offen  lds
    s_waitcnt vmcnt(9)
    s_barrier
    s_addk_i32 m0, 1056
    s_addk_i32 s52, 7168
    buffer_load_dwordx4 v8, s[24:27], s52 offen  lds
    s_addk_i32 m0, 1056
    s_addk_i32 s52, 7168
    buffer_load_dwordx4 v8, s[24:27], s52 offen  lds
    s_addk_i32 m0, 1056
    s_addk_i32 s52, 7168
    buffer_load_dwordx4 v8, s[24:27], s52 offen  lds
    s_addk_i32 m0, 1056
    s_addk_i32 s52, 7168
    buffer_load_dwordx4 v8, s[24:27], s52 offen  lds
    s_addk_i32 m0, 1056
    s_addk_i32 s52, 7168
    buffer_load_dwordx4 v8, s[24:27], s52 offen  lds
    s_mov_b32 m0, s49
    s_mov_b64 exec, 15
    buffer_load_dwordx4 v10, s[24:27], s54 offen  lds
    s_mov_b64 exec, -1
    s_addk_i32 s54, 128
    s_cmpk_eq_u32 s54, 896
    s_cselect_b32 s54, 0, s54
    s_add_u32 m0, s51, 24576
    s_mov_b32 s58, s55
    buffer_load_dwordx4 v11, s[28:31], s58 offen  lds
    s_addk_i32 m0, 4096
    s_add_u32 s58, s58, s41
    buffer_load_dwordx4 v11, s[28:31], s58 offen  lds
    s_addk_i32 m0, 4096
    s_add_u32 s58, s58, s41
    buffer_load_dwordx4 v11, s[28:31], s58 offen  lds
    s_addk_i32 s55, 28672
    s_cmp_eq_u32 s55, s41
    s_cselect_b32 s55, 0, s55
    s_waitcnt vmcnt(15)
    s_barrier
    s_addk_i32 m0, 4096
    s_mov_b32 s58, s55
    buffer_load_dwordx4 v11, s[28:31], s58 offen  lds
    s_addk_i32 m0, 4096
    s_add_u32 s58, s58, s41
    buffer_load_dwordx4 v11, s[28:31], s58 offen  lds
    s_addk_i32 m0, 4096
    s_add_u32 s58, s58, s41
    buffer_load_dwordx4 v11, s[28:31], s58 offen  lds
    s_addk_i32 s55, 28672
    s_add_u32 m0, s50, 34080
    s_mov_b32 s52, s54
    buffer_load_dwordx4 v8, s[24:27], s52 offen  lds
    s_addk_i32 m0, 1056
    s_addk_i32 s52, 7168
    buffer_load_dwordx4 v8, s[24:27], s52 offen  lds
    s_addk_i32 m0, 1056
    s_addk_i32 s52, 7168
    buffer_load_dwordx4 v8, s[24:27], s52 offen  lds
    s_addk_i32 m0, 1056
    s_addk_i32 s52, 7168
    buffer_load_dwordx4 v8, s[24:27], s52 offen  lds
    s_addk_i32 m0, 1056
    s_addk_i32 s52, 7168
    buffer_load_dwordx4 v8, s[24:27], s52 offen  lds
    s_addk_i32 m0, 1056
    s_addk_i32 s52, 7168
    buffer_load_dwordx4 v8, s[24:27], s52 offen  lds
    s_waitcnt vmcnt(12)
    s_barrier
    s_addk_i32 m0, 1056
    s_addk_i32 s52, 7168
    buffer_load_dwordx4 v8, s[24:27], s52 offen  lds
    s_addk_i32 m0, 1056
    s_addk_i32 s52, 7168
    buffer_load_dwordx4 v8, s[24:27], s52 offen  lds
    s_add_u32 m0, s49, 34080
    s_mov_b64 exec, 15
    buffer_load_dwordx4 v10, s[24:27], s54 offen  lds
    s_mov_b64 exec, -1
    s_addk_i32 s54, 128
    s_cmpk_eq_u32 s54, 896
    s_cselect_b32 s54, 0, s54
    s_add_u32 m0, s51, 49152
    s_mov_b32 s58, s55
    buffer_load_dwordx4 v11, s[28:31], s58 offen  lds
    s_addk_i32 m0, 4096
    s_add_u32 s58, s58, s41
    buffer_load_dwordx4 v11, s[28:31], s58 offen  lds
    s_addk_i32 m0, 4096
    s_add_u32 s58, s58, s41
    buffer_load_dwordx4 v11, s[28:31], s58 offen  lds
    s_addk_i32 s55, 28672
    s_cmp_eq_u32 s55, s41
    s_cselect_b32 s55, 0, s55
    s_mov_b32 m0, s51
    s_mov_b32 s58, s55
    buffer_load_dwordx4 v11, s[28:31], s58 offen  lds
    s_addk_i32 m0, 4096
    s_add_u32 s58, s58, s41
    buffer_load_dwordx4 v11, s[28:31], s58 offen  lds
    s_addk_i32 m0, 4096
    s_add_u32 s58, s58, s41
    buffer_load_dwordx4 v11, s[28:31], s58 offen  lds
    s_addk_i32 s55, 28672
    s_add_u32 m0, s50, 68160
    s_mov_b32 s52, s54
    buffer_load_dwordx4 v8, s[24:27], s52 offen  lds
    s_waitcnt vmcnt(19)
    s_barrier
    s_addk_i32 m0, 1056
    s_addk_i32 s52, 7168
    buffer_load_dwordx4 v8, s[24:27], s52 offen  lds
    s_addk_i32 m0, 1056
    s_addk_i32 s52, 7168
    buffer_load_dwordx4 v8, s[24:27], s52 offen  lds
    s_addk_i32 m0, 1056
    s_addk_i32 s52, 7168
    buffer_load_dwordx4 v8, s[24:27], s52 offen  lds
    s_addk_i32 m0, 1056
    s_addk_i32 s52, 7168
    buffer_load_dwordx4 v8, s[24:27], s52 offen  lds
    s_addk_i32 m0, 1056
    s_addk_i32 s52, 7168
    buffer_load_dwordx4 v8, s[24:27], s52 offen  lds
    s_addk_i32 m0, 1056
    s_addk_i32 s52, 7168
    buffer_load_dwordx4 v8, s[24:27], s52 offen  lds
    s_addk_i32 m0, 1056
    s_addk_i32 s52, 7168
    buffer_load_dwordx4 v8, s[24:27], s52 offen  lds
    s_add_u32 m0, s49, 68160
    s_mov_b64 exec, 15
    buffer_load_dwordx4 v10, s[24:27], s54 offen  lds
    s_mov_b64 exec, -1
    s_addk_i32 s54, 128
    s_cmpk_eq_u32 s54, 896
    s_cselect_b32 s54, 0, s54
    s_add_u32 m0, s51, 12288
    s_mov_b32 s58, s55
    buffer_load_dwordx4 v11, s[28:31], s58 offen  lds
    s_addk_i32 m0, 4096
    s_add_u32 s58, s58, s41
    buffer_load_dwordx4 v11, s[28:31], s58 offen  lds
    s_waitcnt vmcnt(17)
    s_barrier
    s_addk_i32 m0, 4096
    s_add_u32 s58, s58, s41
    buffer_load_dwordx4 v11, s[28:31], s58 offen  lds
    s_addk_i32 s55, 28672
    s_cmp_eq_u32 s55, s41
    s_cselect_b32 s55, 0, s55
    s_addk_i32 m0, 4096
    s_mov_b32 s58, s55
    buffer_load_dwordx4 v11, s[28:31], s58 offen  lds
    s_addk_i32 m0, 4096
    s_add_u32 s58, s58, s41
    buffer_load_dwordx4 v11, s[28:31], s58 offen  lds
    s_addk_i32 m0, 4096
    s_add_u32 s58, s58, s41
    buffer_load_dwordx4 v11, s[28:31], s58 offen  lds
    s_addk_i32 s55, 28672
    s_mov_b32 m0, s50
    s_mov_b32 s52, s54
    buffer_load_dwordx4 v8, s[24:27], s52 offen  lds
    s_addk_i32 m0, 1056
    s_addk_i32 s52, 7168
    buffer_load_dwordx4 v8, s[24:27], s52 offen  lds
    s_addk_i32 m0, 1056
    s_addk_i32 s52, 7168
    buffer_load_dwordx4 v8, s[24:27], s52 offen  lds
    s_addk_i32 m0, 1056
    s_addk_i32 s52, 7168
    buffer_load_dwordx4 v8, s[24:27], s52 offen  lds
    s_addk_i32 m0, 1056
    s_addk_i32 s52, 7168
    buffer_load_dwordx4 v8, s[24:27], s52 offen  lds
    s_waitcnt vmcnt(23)
    s_barrier
    s_addk_i32 m0, 1056
    s_addk_i32 s52, 7168
    buffer_load_dwordx4 v8, s[24:27], s52 offen  lds
    s_addk_i32 m0, 1056
    s_addk_i32 s52, 7168
    buffer_load_dwordx4 v8, s[24:27], s52 offen  lds
    s_addk_i32 m0, 1056
    s_addk_i32 s52, 7168
    buffer_load_dwordx4 v8, s[24:27], s52 offen  lds
    s_mov_b32 m0, s49
    s_mov_b64 exec, 15
    buffer_load_dwordx4 v10, s[24:27], s54 offen  lds
    s_mov_b64 exec, -1
    s_add_u32 m0, s51, 36864
    s_mov_b32 s58, s55
    buffer_load_dwordx4 v11, s[28:31], s58 offen  lds
    s_addk_i32 m0, 4096
    s_add_u32 s58, s58, s41
    buffer_load_dwordx4 v11, s[28:31], s58 offen  lds
    s_addk_i32 m0, 4096
    s_add_u32 s58, s58, s41
    buffer_load_dwordx4 v11, s[28:31], s58 offen  lds
    s_waitcnt vmcnt(18)
    s_barrier
    s_waitcnt vmcnt(15)
    s_barrier
    s_waitcnt vmcnt(3)
    s_barrier
    s_waitcnt vmcnt(0)
    s_barrier
    s_branch L_loader3
.p2align 12
L_consumer:
    s_and_b32 s41, s40, 1
    s_lshr_b32 s40, s40, 1
    v_and_b32 v17, 15, v0
    v_lshrrev_b32 v18, 4, v0
    s_lshl_b32 s42, s40, 4
    v_add_u32 v17, s42, v17
    v_mul_u32_u24 v19, 1056, v17
    v_lshl_add_u32 v19, v18, 4, v19
    v_add_u32 v1, 61440, v19
    v_mov_b32 v2, v1
    v_lshlrev_b32 v19, 7, v17
    v_add_u32 v19, 61440, v19
    v_add_u32 v20, -1, v17
    v_and_b32 v20, 6, v20
    v_xor_b32 v20, v20, v18
    v_lshl_add_u32 v8, v20, 4, v19
    v_xor_b32 v9, 64, v8
    v_add_u32 v20, 0, v17
    v_and_b32 v20, 6, v20
    v_xor_b32 v20, v20, v18
    v_lshl_add_u32 v10, v20, 4, v19
    v_xor_b32 v11, 64, v10
    v_add_u32 v20, 1, v17
    v_and_b32 v20, 6, v20
    v_xor_b32 v20, v20, v18
    v_lshl_add_u32 v12, v20, 4, v19
    v_xor_b32 v13, 64, v12
    v_bfe_u32 v20, v0, 2, 2
    v_lshl_add_u32 v21, v18, 3, v20
    v_lshlrev_b32 v21, 7, v21
    v_bfe_u32 v20, v0, 3, 2
    s_lshl_b32 s42, s41, 1
    v_xor_b32 v20, s42, v20
    v_lshl_add_u32 v21, v20, 5, v21
    v_and_b32 v20, 3, v0
    v_lshl_add_u32 v3, v20, 3, v21
    v_xor_b32 v4, 32, v3
    v_mul_u32_u24 v20, 7168, v17
    v_and_b32 v21, 1, v18
    v_lshl_add_u32 v20, v21, 5, v20
    v_lshrrev_b32 v21, 1, v18
    v_lshl_add_u32 v20, v21, 4, v20
    s_lshl_b32 s42, s41, 6
    s_add_u32 s42, s42, s39
    s_add_u32 s42, s42, s38
    v_add_u32 v5, s42, v20
    v_lshrrev_b32 v20, 1, v18
    v_mul_u32_u24 v20, 1056, v20
    v_and_b32 v21, 1, v18
    v_lshl_add_u32 v20, v21, 4, v20
    s_mul_i32 s42, s41, 4224
    s_add_u32 s42, s42, 130784
    v_add_u32 v6, s42, v20
    v_and_b32 v20, 15, v17
    v_lshl_add_u32 v20, v18, 4, v20
    v_lshlrev_b32 v29, 1, v20
    v_add_u32 v29, s39, v29
    v_lshrrev_b32 v21, 3, v20
    v_mul_u32_u24 v21, 1056, v21
    v_and_b32 v20, 7, v20
    v_lshl_add_u32 v20, v20, 2, v21
    v_add_u32 v28, 130784, v20
    s_mov_b32 s44, 0xbfb8aa3b
    s_mov_b32 s45, s44
    s_mov_b32 s46, 3584
    s_waitcnt lgkmcnt(0)
    global_load_ushort v24, v29, s[8:9]
    global_load_ushort v25, v29, s[10:11]
    global_load_ushort v26, v29, s[12:13]
    global_load_ushort v27, v29, s[14:15]
    s_cmp_lg_u32 s40, s40
    s_barrier
    ds_read_b64_tr_b16 v[168:169], v3 offset:0
    ds_read_b64_tr_b16 v[170:171], v3 offset:512
    ds_read_b128 v[128:131], v8 offset:0
    ds_read_b64_tr_b16 v[176:177], v3 offset:4096
    ds_read_b64_tr_b16 v[178:179], v3 offset:4608
    ds_read_b128 v[132:135], v10 offset:28800
    ds_read_b64_tr_b16 v[184:185], v3 offset:8192
    ds_read_b64_tr_b16 v[186:187], v3 offset:8704
    ds_read_b128 v[136:139], v10 offset:24704
    ds_read_b64_tr_b16 v[172:173], v4 offset:0
    ds_read_b64_tr_b16 v[174:175], v4 offset:512
    s_waitcnt lgkmcnt(8)
    v_mfma_f32_16x16x32_bf16 v[64:67], v[168:171], v[128:131], 0
    ds_read_b64_tr_b16 v[180:181], v4 offset:4096
    ds_read_b64_tr_b16 v[182:183], v4 offset:4608
    s_waitcnt lgkmcnt(7)
    v_mfma_f32_16x16x32_bf16 v[64:67], v[176:179], v[132:135], v[64:67]
    ds_read_b64_tr_b16 v[188:189], v4 offset:8192
    ds_read_b64_tr_b16 v[190:191], v4 offset:8704
    s_waitcnt lgkmcnt(6)
    v_mfma_f32_16x16x32_bf16 v[64:67], v[184:187], v[136:139], v[64:67]
    s_barrier
    ds_read_b128 v[140:143], v10 offset:20608
    s_waitcnt lgkmcnt(5)
    v_mfma_f32_16x16x32_bf16 v[68:71], v[172:175], v[128:131], 0
    ds_read_b128 v[144:147], v10 offset:16512
    s_waitcnt lgkmcnt(4)
    v_mfma_f32_16x16x32_bf16 v[68:71], v[180:183], v[132:135], v[68:71]
    s_waitcnt lgkmcnt(2)
    v_mfma_f32_16x16x32_bf16 v[68:71], v[188:191], v[136:139], v[68:71]
    v_mfma_f32_16x16x32_bf16 v[72:75], v[168:171], v[132:135], 0
    v_mfma_f32_16x16x32_bf16 v[72:75], v[176:179], v[136:139], v[72:75]
    s_waitcnt lgkmcnt(1)
    v_mfma_f32_16x16x32_bf16 v[72:75], v[184:187], v[140:143], v[72:75]
    v_mfma_f32_16x16x32_bf16 v[76:79], v[172:175], v[132:135], 0
    v_mfma_f32_16x16x32_bf16 v[76:79], v[180:183], v[136:139], v[76:79]
    v_mfma_f32_16x16x32_bf16 v[76:79], v[188:191], v[140:143], v[76:79]
    s_barrier
    ds_read_b128 v[148:151], v10 offset:12416
    v_mfma_f32_16x16x32_bf16 v[80:83], v[168:171], v[136:139], 0
    ds_read_b128 v[152:155], v10 offset:8320
    v_mfma_f32_16x16x32_bf16 v[80:83], v[176:179], v[140:143], v[80:83]
    ds_read_b128 v[156:159], v10 offset:4224
    s_waitcnt lgkmcnt(3)
    v_mfma_f32_16x16x32_bf16 v[80:83], v[184:187], v[144:147], v[80:83]
    ds_read_b128 v[160:163], v10 offset:128
    v_mfma_f32_16x16x32_bf16 v[84:87], v[172:175], v[136:139], 0
    ds_read_b128 v[164:167], v12 offset:28928
    v_mfma_f32_16x16x32_bf16 v[84:87], v[180:183], v[140:143], v[84:87]
    v_mfma_f32_16x16x32_bf16 v[84:87], v[188:191], v[144:147], v[84:87]
    v_mfma_f32_16x16x32_bf16 v[88:91], v[168:171], v[140:143], 0
    v_mfma_f32_16x16x32_bf16 v[88:91], v[176:179], v[144:147], v[88:91]
    s_waitcnt lgkmcnt(4)
    v_mfma_f32_16x16x32_bf16 v[88:91], v[184:187], v[148:151], v[88:91]
    v_mfma_f32_16x16x32_bf16 v[92:95], v[172:175], v[140:143], 0
    v_mfma_f32_16x16x32_bf16 v[92:95], v[180:183], v[144:147], v[92:95]
    v_mfma_f32_16x16x32_bf16 v[92:95], v[188:191], v[148:151], v[92:95]
    v_mfma_f32_16x16x32_bf16 v[96:99], v[168:171], v[144:147], 0
    v_mfma_f32_16x16x32_bf16 v[96:99], v[176:179], v[148:151], v[96:99]
    s_waitcnt lgkmcnt(0)
    s_barrier
    v_mfma_f32_16x16x32_bf16 v[96:99], v[184:187], v[152:155], v[96:99]
    ds_read_b64_tr_b16 v[232:233], v3 offset:12288
    v_mfma_f32_16x16x32_bf16 v[100:103], v[172:175], v[144:147], 0
    ds_read_b64_tr_b16 v[234:235], v3 offset:12800
    v_mfma_f32_16x16x32_bf16 v[100:103], v[180:183], v[148:151], v[100:103]
    ds_read_b128 v[192:195], v9 offset:0
    v_mfma_f32_16x16x32_bf16 v[100:103], v[188:191], v[152:155], v[100:103]
    ds_read_b64_tr_b16 v[240:241], v3 offset:16384
    v_mfma_f32_16x16x32_bf16 v[104:107], v[168:171], v[148:151], 0
    ds_read_b64_tr_b16 v[242:243], v3 offset:16896
    v_mfma_f32_16x16x32_bf16 v[104:107], v[176:179], v[152:155], v[104:107]
    ds_read_b128 v[196:199], v11 offset:28800
    v_mfma_f32_16x16x32_bf16 v[104:107], v[184:187], v[156:159], v[104:107]
    ds_read_b64_tr_b16 v[248:249], v3 offset:20480
    v_mfma_f32_16x16x32_bf16 v[108:111], v[172:175], v[148:151], 0
    ds_read_b64_tr_b16 v[250:251], v3 offset:20992
    v_mfma_f32_16x16x32_bf16 v[108:111], v[180:183], v[152:155], v[108:111]
    ds_read_b128 v[200:203], v11 offset:24704
    v_mfma_f32_16x16x32_bf16 v[108:111], v[188:191], v[156:159], v[108:111]
    ds_read_b64_tr_b16 v[236:237], v4 offset:12288
    v_mfma_f32_16x16x32_bf16 v[112:115], v[168:171], v[152:155], 0
    ds_read_b64_tr_b16 v[238:239], v4 offset:12800
    v_mfma_f32_16x16x32_bf16 v[112:115], v[176:179], v[156:159], v[112:115]
    ds_read_b64_tr_b16 v[244:245], v4 offset:16384
    v_mfma_f32_16x16x32_bf16 v[112:115], v[184:187], v[160:163], v[112:115]
    ds_read_b64_tr_b16 v[246:247], v4 offset:16896
    v_mfma_f32_16x16x32_bf16 v[116:119], v[172:175], v[152:155], 0
    ds_read_b64_tr_b16 v[252:253], v4 offset:20480
    v_mfma_f32_16x16x32_bf16 v[116:119], v[180:183], v[156:159], v[116:119]
    ds_read_b64_tr_b16 v[254:255], v4 offset:20992
    v_mfma_f32_16x16x32_bf16 v[116:119], v[188:191], v[160:163], v[116:119]
    ds_read_b128 v[204:207], v11 offset:20608
    v_mfma_f32_16x16x32_bf16 v[120:123], v[168:171], v[156:159], 0
    ds_read_b128 v[208:211], v11 offset:16512
    v_mfma_f32_16x16x32_bf16 v[120:123], v[176:179], v[160:163], v[120:123]
    ds_read_b128 v[212:215], v11 offset:12416
    v_mfma_f32_16x16x32_bf16 v[120:123], v[184:187], v[164:167], v[120:123]
    ds_read_b128 v[216:219], v11 offset:8320
    v_mfma_f32_16x16x32_bf16 v[124:127], v[172:175], v[156:159], 0
    ds_read_b128 v[220:223], v11 offset:4224
    v_mfma_f32_16x16x32_bf16 v[124:127], v[180:183], v[160:163], v[124:127]
    ds_read_b128 v[224:227], v11 offset:128
    v_mfma_f32_16x16x32_bf16 v[124:127], v[188:191], v[164:167], v[124:127]
    ds_read_b128 v[228:231], v13 offset:28928
    s_waitcnt lgkmcnt(14)
    v_mfma_f32_16x16x32_bf16 v[64:67], v[232:235], v[192:195], v[64:67]
    v_mfma_f32_16x16x32_bf16 v[64:67], v[240:243], v[196:199], v[64:67]
    s_waitcnt lgkmcnt(13)
    v_mfma_f32_16x16x32_bf16 v[64:67], v[248:251], v[200:203], v[64:67]
    s_waitcnt lgkmcnt(11)
    v_mfma_f32_16x16x32_bf16 v[68:71], v[236:239], v[192:195], v[68:71]
    s_waitcnt lgkmcnt(9)
    v_mfma_f32_16x16x32_bf16 v[68:71], v[244:247], v[196:199], v[68:71]
    s_waitcnt lgkmcnt(7)
    v_mfma_f32_16x16x32_bf16 v[68:71], v[252:255], v[200:203], v[68:71]
    v_mfma_f32_16x16x32_bf16 v[72:75], v[232:235], v[196:199], v[72:75]
    v_mfma_f32_16x16x32_bf16 v[72:75], v[240:243], v[200:203], v[72:75]
    s_waitcnt lgkmcnt(6)
    v_mfma_f32_16x16x32_bf16 v[72:75], v[248:251], v[204:207], v[72:75]
    v_mfma_f32_16x16x32_bf16 v[76:79], v[236:239], v[196:199], v[76:79]
    v_mfma_f32_16x16x32_bf16 v[76:79], v[244:247], v[200:203], v[76:79]
    v_mfma_f32_16x16x32_bf16 v[76:79], v[252:255], v[204:207], v[76:79]
    v_mfma_f32_16x16x32_bf16 v[80:83], v[232:235], v[200:203], v[80:83]
    v_mfma_f32_16x16x32_bf16 v[80:83], v[240:243], v[204:207], v[80:83]
    s_waitcnt lgkmcnt(5)
    v_mfma_f32_16x16x32_bf16 v[80:83], v[248:251], v[208:211], v[80:83]
    v_mfma_f32_16x16x32_bf16 v[84:87], v[236:239], v[200:203], v[84:87]
    v_mfma_f32_16x16x32_bf16 v[84:87], v[244:247], v[204:207], v[84:87]
    v_mfma_f32_16x16x32_bf16 v[84:87], v[252:255], v[208:211], v[84:87]
    v_mfma_f32_16x16x32_bf16 v[88:91], v[232:235], v[204:207], v[88:91]
    v_mfma_f32_16x16x32_bf16 v[88:91], v[240:243], v[208:211], v[88:91]
    s_waitcnt lgkmcnt(4)
    v_mfma_f32_16x16x32_bf16 v[88:91], v[248:251], v[212:215], v[88:91]
    v_mfma_f32_16x16x32_bf16 v[92:95], v[236:239], v[204:207], v[92:95]
    v_mfma_f32_16x16x32_bf16 v[92:95], v[244:247], v[208:211], v[92:95]
    v_mfma_f32_16x16x32_bf16 v[92:95], v[252:255], v[212:215], v[92:95]
    v_mfma_f32_16x16x32_bf16 v[96:99], v[232:235], v[208:211], v[96:99]
    v_add_u32 v1, 34080, v1
    v_mfma_f32_16x16x32_bf16 v[96:99], v[240:243], v[212:215], v[96:99]
    s_waitcnt lgkmcnt(0)
    s_barrier
    v_mfma_f32_16x16x32_bf16 v[96:99], v[248:251], v[216:219], v[96:99]
    ds_read_b64_tr_b16 v[168:169], v3 offset:24576
    v_mfma_f32_16x16x32_bf16 v[100:103], v[236:239], v[208:211], v[100:103]
    ds_read_b64_tr_b16 v[170:171], v3 offset:25088
    v_mfma_f32_16x16x32_bf16 v[100:103], v[244:247], v[212:215], v[100:103]
    ds_read_b128 v[128:131], v1 offset:0
    v_mfma_f32_16x16x32_bf16 v[100:103], v[252:255], v[216:219], v[100:103]
    ds_read_b64_tr_b16 v[176:177], v3 offset:28672
    v_mfma_f32_16x16x32_bf16 v[104:107], v[232:235], v[212:215], v[104:107]
    ds_read_b64_tr_b16 v[178:179], v3 offset:29184
    v_mfma_f32_16x16x32_bf16 v[104:107], v[240:243], v[216:219], v[104:107]
    ds_read_b128 v[132:135], v1 offset:160
    v_mfma_f32_16x16x32_bf16 v[104:107], v[248:251], v[220:223], v[104:107]
    ds_read_b64_tr_b16 v[184:185], v3 offset:32768
    v_mfma_f32_16x16x32_bf16 v[108:111], v[236:239], v[212:215], v[108:111]
    ds_read_b64_tr_b16 v[186:187], v3 offset:33280
    v_mfma_f32_16x16x32_bf16 v[108:111], v[244:247], v[216:219], v[108:111]
    ds_read_b128 v[136:139], v1 offset:288
    v_mfma_f32_16x16x32_bf16 v[108:111], v[252:255], v[220:223], v[108:111]
    ds_read_b64_tr_b16 v[172:173], v4 offset:24576
    v_mfma_f32_16x16x32_bf16 v[112:115], v[232:235], v[216:219], v[112:115]
    ds_read_b64_tr_b16 v[174:175], v4 offset:25088
    v_mfma_f32_16x16x32_bf16 v[112:115], v[240:243], v[220:223], v[112:115]
    ds_read_b64_tr_b16 v[180:181], v4 offset:28672
    v_mfma_f32_16x16x32_bf16 v[112:115], v[248:251], v[224:227], v[112:115]
    ds_read_b64_tr_b16 v[182:183], v4 offset:29184
    v_mfma_f32_16x16x32_bf16 v[116:119], v[236:239], v[216:219], v[116:119]
    ds_read_b64_tr_b16 v[188:189], v4 offset:32768
    v_mfma_f32_16x16x32_bf16 v[116:119], v[244:247], v[220:223], v[116:119]
    ds_read_b64_tr_b16 v[190:191], v4 offset:33280
    v_mfma_f32_16x16x32_bf16 v[116:119], v[252:255], v[224:227], v[116:119]
    ds_read_b128 v[140:143], v1 offset:416
    v_mfma_f32_16x16x32_bf16 v[120:123], v[232:235], v[220:223], v[120:123]
    ds_read_b128 v[144:147], v1 offset:544
    v_mfma_f32_16x16x32_bf16 v[120:123], v[240:243], v[224:227], v[120:123]
    ds_read_b128 v[148:151], v1 offset:672
    v_mfma_f32_16x16x32_bf16 v[120:123], v[248:251], v[228:231], v[120:123]
    ds_read_b128 v[152:155], v1 offset:800
    v_mfma_f32_16x16x32_bf16 v[124:127], v[236:239], v[220:223], v[124:127]
    ds_read_b128 v[156:159], v1 offset:928
    v_mfma_f32_16x16x32_bf16 v[124:127], v[244:247], v[224:227], v[124:127]
    ds_read_b128 v[160:163], v1 offset:1056
    v_mfma_f32_16x16x32_bf16 v[124:127], v[252:255], v[228:231], v[124:127]
    ds_read_b128 v[164:167], v1 offset:1216
    s_waitcnt lgkmcnt(14)
    v_mfma_f32_16x16x32_bf16 v[64:67], v[168:171], v[128:131], v[64:67]
    v_mfma_f32_16x16x32_bf16 v[64:67], v[176:179], v[132:135], v[64:67]
    s_waitcnt lgkmcnt(13)
    v_mfma_f32_16x16x32_bf16 v[64:67], v[184:187], v[136:139], v[64:67]
    s_waitcnt lgkmcnt(11)
    v_mfma_f32_16x16x32_bf16 v[68:71], v[172:175], v[128:131], v[68:71]
    s_waitcnt lgkmcnt(9)
    v_mfma_f32_16x16x32_bf16 v[68:71], v[180:183], v[132:135], v[68:71]
    s_waitcnt lgkmcnt(7)
    v_mfma_f32_16x16x32_bf16 v[68:71], v[188:191], v[136:139], v[68:71]
    v_mfma_f32_16x16x32_bf16 v[72:75], v[168:171], v[132:135], v[72:75]
    v_mfma_f32_16x16x32_bf16 v[72:75], v[176:179], v[136:139], v[72:75]
    s_waitcnt lgkmcnt(6)
    v_mfma_f32_16x16x32_bf16 v[72:75], v[184:187], v[140:143], v[72:75]
    v_mfma_f32_16x16x32_bf16 v[76:79], v[172:175], v[132:135], v[76:79]
    v_mfma_f32_16x16x32_bf16 v[76:79], v[180:183], v[136:139], v[76:79]
    v_mfma_f32_16x16x32_bf16 v[76:79], v[188:191], v[140:143], v[76:79]
    v_mfma_f32_16x16x32_bf16 v[80:83], v[168:171], v[136:139], v[80:83]
    v_mfma_f32_16x16x32_bf16 v[80:83], v[176:179], v[140:143], v[80:83]
    s_waitcnt lgkmcnt(5)
    v_mfma_f32_16x16x32_bf16 v[80:83], v[184:187], v[144:147], v[80:83]
    v_mfma_f32_16x16x32_bf16 v[84:87], v[172:175], v[136:139], v[84:87]
    v_mfma_f32_16x16x32_bf16 v[84:87], v[180:183], v[140:143], v[84:87]
    v_mfma_f32_16x16x32_bf16 v[84:87], v[188:191], v[144:147], v[84:87]
    v_mfma_f32_16x16x32_bf16 v[88:91], v[168:171], v[140:143], v[88:91]
    v_mfma_f32_16x16x32_bf16 v[88:91], v[176:179], v[144:147], v[88:91]
    s_waitcnt lgkmcnt(4)
    v_mfma_f32_16x16x32_bf16 v[88:91], v[184:187], v[148:151], v[88:91]
    s_waitcnt lgkmcnt(0)
    s_barrier
    v_mfma_f32_16x16x32_bf16 v[92:95], v[172:175], v[140:143], v[92:95]
    ds_read_b64_tr_b16 v[232:233], v3 offset:36864
    v_mfma_f32_16x16x32_bf16 v[92:95], v[180:183], v[144:147], v[92:95]
    ds_read_b64_tr_b16 v[234:235], v3 offset:37376
    v_mfma_f32_16x16x32_bf16 v[92:95], v[188:191], v[148:151], v[92:95]
    ds_read_b128 v[192:195], v1 offset:64
    v_mfma_f32_16x16x32_bf16 v[96:99], v[168:171], v[144:147], v[96:99]
    ds_read_b64_tr_b16 v[240:241], v3 offset:40960
    v_mfma_f32_16x16x32_bf16 v[96:99], v[176:179], v[148:151], v[96:99]
    ds_read_b64_tr_b16 v[242:243], v3 offset:41472
    v_mfma_f32_16x16x32_bf16 v[96:99], v[184:187], v[152:155], v[96:99]
    ds_read_b128 v[196:199], v1 offset:224
    v_mfma_f32_16x16x32_bf16 v[100:103], v[172:175], v[144:147], v[100:103]
    ds_read_b64_tr_b16 v[248:249], v3 offset:45056
    v_mfma_f32_16x16x32_bf16 v[100:103], v[180:183], v[148:151], v[100:103]
    ds_read_b64_tr_b16 v[250:251], v3 offset:45568
    v_mfma_f32_16x16x32_bf16 v[100:103], v[188:191], v[152:155], v[100:103]
    ds_read_b128 v[200:203], v1 offset:352
    v_mfma_f32_16x16x32_bf16 v[104:107], v[168:171], v[148:151], v[104:107]
    ds_read_b64_tr_b16 v[236:237], v4 offset:36864
    v_mfma_f32_16x16x32_bf16 v[104:107], v[176:179], v[152:155], v[104:107]
    ds_read_b64_tr_b16 v[238:239], v4 offset:37376
    v_mfma_f32_16x16x32_bf16 v[104:107], v[184:187], v[156:159], v[104:107]
    ds_read_b64_tr_b16 v[244:245], v4 offset:40960
    v_mfma_f32_16x16x32_bf16 v[108:111], v[172:175], v[148:151], v[108:111]
    ds_read_b64_tr_b16 v[246:247], v4 offset:41472
    v_mfma_f32_16x16x32_bf16 v[108:111], v[180:183], v[152:155], v[108:111]
    ds_read_b64_tr_b16 v[252:253], v4 offset:45056
    v_mfma_f32_16x16x32_bf16 v[108:111], v[188:191], v[156:159], v[108:111]
    ds_read_b64_tr_b16 v[254:255], v4 offset:45568
    v_mfma_f32_16x16x32_bf16 v[112:115], v[168:171], v[152:155], v[112:115]
    ds_read_b128 v[204:207], v1 offset:480
    v_mfma_f32_16x16x32_bf16 v[112:115], v[176:179], v[156:159], v[112:115]
    ds_read_b128 v[208:211], v1 offset:608
    v_mfma_f32_16x16x32_bf16 v[112:115], v[184:187], v[160:163], v[112:115]
    ds_read_b128 v[212:215], v1 offset:736
    v_mfma_f32_16x16x32_bf16 v[116:119], v[172:175], v[152:155], v[116:119]
    ds_read_b128 v[216:219], v1 offset:864
    v_mfma_f32_16x16x32_bf16 v[116:119], v[180:183], v[156:159], v[116:119]
    ds_read_b128 v[220:223], v1 offset:992
    v_mfma_f32_16x16x32_bf16 v[116:119], v[188:191], v[160:163], v[116:119]
    ds_read_b128 v[224:227], v1 offset:1120
    v_mfma_f32_16x16x32_bf16 v[120:123], v[168:171], v[156:159], v[120:123]
    ds_read_b128 v[228:231], v1 offset:1280
    v_mfma_f32_16x16x32_bf16 v[120:123], v[176:179], v[160:163], v[120:123]
    v_mfma_f32_16x16x32_bf16 v[120:123], v[184:187], v[164:167], v[120:123]
    v_mfma_f32_16x16x32_bf16 v[124:127], v[172:175], v[156:159], v[124:127]
    v_mfma_f32_16x16x32_bf16 v[124:127], v[180:183], v[160:163], v[124:127]
    v_mfma_f32_16x16x32_bf16 v[124:127], v[188:191], v[164:167], v[124:127]
    s_waitcnt lgkmcnt(14)
    v_mfma_f32_16x16x32_bf16 v[64:67], v[232:235], v[192:195], v[64:67]
    v_mfma_f32_16x16x32_bf16 v[64:67], v[240:243], v[196:199], v[64:67]
    s_waitcnt lgkmcnt(13)
    v_mfma_f32_16x16x32_bf16 v[64:67], v[248:251], v[200:203], v[64:67]
    s_waitcnt lgkmcnt(6)
    v_mfma_f32_16x16x32_bf16 v[72:75], v[248:251], v[204:207], v[72:75]
    v_mfma_f32_16x16x32_bf16 v[72:75], v[240:243], v[200:203], v[72:75]
    v_mfma_f32_16x16x32_bf16 v[72:75], v[232:235], v[196:199], v[72:75]
    v_mfma_f32_16x16x32_bf16 v[80:83], v[232:235], v[200:203], v[80:83]
    v_mfma_f32_16x16x32_bf16 v[80:83], v[240:243], v[204:207], v[80:83]
    s_waitcnt lgkmcnt(5)
    v_mfma_f32_16x16x32_bf16 v[80:83], v[248:251], v[208:211], v[80:83]
    s_waitcnt lgkmcnt(4)
    v_mfma_f32_16x16x32_bf16 v[88:91], v[248:251], v[212:215], v[88:91]
    v_mfma_f32_16x16x32_bf16 v[88:91], v[240:243], v[208:211], v[88:91]
    v_mfma_f32_16x16x32_bf16 v[88:91], v[232:235], v[204:207], v[88:91]
    v_mfma_f32_16x16x32_bf16 v[96:99], v[232:235], v[208:211], v[96:99]
    v_mfma_f32_16x16x32_bf16 v[96:99], v[240:243], v[212:215], v[96:99]
    s_waitcnt lgkmcnt(3)
    v_mfma_f32_16x16x32_bf16 v[96:99], v[248:251], v[216:219], v[96:99]
    s_waitcnt lgkmcnt(2)
    v_mfma_f32_16x16x32_bf16 v[104:107], v[248:251], v[220:223], v[104:107]
    v_add_u32 v1, 34080, v1
    v_mfma_f32_16x16x32_bf16 v[104:107], v[240:243], v[216:219], v[104:107]
    s_waitcnt lgkmcnt(0)
    s_barrier
    v_mfma_f32_16x16x32_bf16 v[104:107], v[232:235], v[212:215], v[104:107]
    ds_read_b64_tr_b16 v[168:169], v3 offset:49152
    v_mfma_f32_16x16x32_bf16 v[112:115], v[232:235], v[216:219], v[112:115]
    ds_read_b64_tr_b16 v[170:171], v3 offset:49664
    v_mfma_f32_16x16x32_bf16 v[112:115], v[240:243], v[220:223], v[112:115]
    ds_read_b128 v[128:131], v1 offset:0
    v_mfma_f32_16x16x32_bf16 v[112:115], v[248:251], v[224:227], v[112:115]
    ds_read_b64_tr_b16 v[176:177], v3 offset:53248
    v_mfma_f32_16x16x32_bf16 v[120:123], v[248:251], v[228:231], v[120:123]
    ds_read_b64_tr_b16 v[178:179], v3 offset:53760
    v_mfma_f32_16x16x32_bf16 v[120:123], v[240:243], v[224:227], v[120:123]
    ds_read_b128 v[132:135], v1 offset:160
    v_mfma_f32_16x16x32_bf16 v[120:123], v[232:235], v[220:223], v[120:123]
    ds_read_b64_tr_b16 v[184:185], v3 offset:57344
    v_mfma_f32_16x16x32_bf16 v[68:71], v[236:239], v[192:195], v[68:71]
    ds_read_b64_tr_b16 v[186:187], v3 offset:57856
    v_mfma_f32_16x16x32_bf16 v[68:71], v[244:247], v[196:199], v[68:71]
    v_mfma_f32_16x16x32_bf16 v[68:71], v[252:255], v[200:203], v[68:71]
    ds_read_b128 v[136:139], v1 offset:288
    v_mfma_f32_16x16x32_bf16 v[76:79], v[252:255], v[204:207], v[76:79]
    ds_read_b64_tr_b16 v[172:173], v4 offset:49152
    v_mfma_f32_16x16x32_bf16 v[76:79], v[244:247], v[200:203], v[76:79]
    ds_read_b64_tr_b16 v[174:175], v4 offset:49664
    v_mfma_f32_16x16x32_bf16 v[76:79], v[236:239], v[196:199], v[76:79]
    ds_read_b64_tr_b16 v[180:181], v4 offset:53248
    v_mfma_f32_16x16x32_bf16 v[84:87], v[236:239], v[200:203], v[84:87]
    ds_read_b64_tr_b16 v[182:183], v4 offset:53760
    v_mfma_f32_16x16x32_bf16 v[84:87], v[244:247], v[204:207], v[84:87]
    ds_read_b64_tr_b16 v[188:189], v4 offset:57344
    v_mfma_f32_16x16x32_bf16 v[84:87], v[252:255], v[208:211], v[84:87]
    ds_read_b64_tr_b16 v[190:191], v4 offset:57856
    v_mfma_f32_16x16x32_bf16 v[92:95], v[252:255], v[212:215], v[92:95]
    v_mfma_f32_16x16x32_bf16 v[92:95], v[244:247], v[208:211], v[92:95]
    ds_read_b128 v[140:143], v1 offset:416
    v_mfma_f32_16x16x32_bf16 v[92:95], v[236:239], v[204:207], v[92:95]
    ds_read_b128 v[144:147], v1 offset:544
    v_mfma_f32_16x16x32_bf16 v[100:103], v[236:239], v[208:211], v[100:103]
    ds_read_b128 v[148:151], v1 offset:672
    v_mfma_f32_16x16x32_bf16 v[100:103], v[244:247], v[212:215], v[100:103]
    ds_read_b128 v[152:155], v1 offset:800
    v_mfma_f32_16x16x32_bf16 v[100:103], v[252:255], v[216:219], v[100:103]
    ds_read_b128 v[156:159], v1 offset:928
    v_mfma_f32_16x16x32_bf16 v[108:111], v[252:255], v[220:223], v[108:111]
    ds_read_b128 v[160:163], v1 offset:1056
    v_mfma_f32_16x16x32_bf16 v[108:111], v[244:247], v[216:219], v[108:111]
    ds_read_b128 v[164:167], v1 offset:1216
    v_mfma_f32_16x16x32_bf16 v[108:111], v[236:239], v[212:215], v[108:111]
    v_mfma_f32_16x16x32_bf16 v[116:119], v[236:239], v[216:219], v[116:119]
    v_mfma_f32_16x16x32_bf16 v[116:119], v[244:247], v[220:223], v[116:119]
    v_mfma_f32_16x16x32_bf16 v[116:119], v[252:255], v[224:227], v[116:119]
    v_mfma_f32_16x16x32_bf16 v[124:127], v[252:255], v[228:231], v[124:127]
    v_mfma_f32_16x16x32_bf16 v[124:127], v[244:247], v[224:227], v[124:127]
    v_mfma_f32_16x16x32_bf16 v[124:127], v[236:239], v[220:223], v[124:127]
    s_waitcnt lgkmcnt(14)
    v_mfma_f32_16x16x32_bf16 v[64:67], v[168:171], v[128:131], v[64:67]
    v_mfma_f32_16x16x32_bf16 v[64:67], v[176:179], v[132:135], v[64:67]
    s_waitcnt lgkmcnt(13)
    v_mfma_f32_16x16x32_bf16 v[64:67], v[184:187], v[136:139], v[64:67]
    s_waitcnt lgkmcnt(6)
    v_mfma_f32_16x16x32_bf16 v[72:75], v[184:187], v[140:143], v[72:75]
    v_mfma_f32_16x16x32_bf16 v[72:75], v[176:179], v[136:139], v[72:75]
    v_mfma_f32_16x16x32_bf16 v[72:75], v[168:171], v[132:135], v[72:75]
    v_mfma_f32_16x16x32_bf16 v[80:83], v[168:171], v[136:139], v[80:83]
    v_mfma_f32_16x16x32_bf16 v[80:83], v[176:179], v[140:143], v[80:83]
    s_waitcnt lgkmcnt(5)
    v_mfma_f32_16x16x32_bf16 v[80:83], v[184:187], v[144:147], v[80:83]
    s_waitcnt lgkmcnt(4)
    v_mfma_f32_16x16x32_bf16 v[88:91], v[184:187], v[148:151], v[88:91]
    v_mfma_f32_16x16x32_bf16 v[88:91], v[176:179], v[144:147], v[88:91]
    v_mfma_f32_16x16x32_bf16 v[88:91], v[168:171], v[140:143], v[88:91]
    v_mfma_f32_16x16x32_bf16 v[96:99], v[168:171], v[144:147], v[96:99]
    s_waitcnt lgkmcnt(0)
    s_barrier
    v_mfma_f32_16x16x32_bf16 v[96:99], v[176:179], v[148:151], v[96:99]
    ds_read_b64_tr_b16 v[232:233], v3 offset:0
    v_mfma_f32_16x16x32_bf16 v[96:99], v[184:187], v[152:155], v[96:99]
    ds_read_b64_tr_b16 v[234:235], v3 offset:512
    v_mfma_f32_16x16x32_bf16 v[104:107], v[184:187], v[156:159], v[104:107]
    ds_read_b128 v[192:195], v1 offset:64
    v_mfma_f32_16x16x32_bf16 v[104:107], v[176:179], v[152:155], v[104:107]
    ds_read_b64_tr_b16 v[240:241], v3 offset:4096
    v_mfma_f32_16x16x32_bf16 v[104:107], v[168:171], v[148:151], v[104:107]
    v_mfma_f32_16x16x32_bf16 v[112:115], v[168:171], v[152:155], v[112:115]
    ds_read_b64_tr_b16 v[242:243], v3 offset:4608
    v_mfma_f32_16x16x32_bf16 v[112:115], v[176:179], v[156:159], v[112:115]
    ds_read_b128 v[196:199], v1 offset:224
    v_mfma_f32_16x16x32_bf16 v[112:115], v[184:187], v[160:163], v[112:115]
    ds_read_b64_tr_b16 v[248:249], v3 offset:8192
    v_mfma_f32_16x16x32_bf16 v[120:123], v[184:187], v[164:167], v[120:123]
    v_mfma_f32_16x16x32_bf16 v[120:123], v[176:179], v[160:163], v[120:123]
    ds_read_b64_tr_b16 v[250:251], v3 offset:8704
    v_mfma_f32_16x16x32_bf16 v[120:123], v[168:171], v[156:159], v[120:123]
    ds_read_b128 v[200:203], v1 offset:352
    v_mfma_f32_16x16x32_bf16 v[68:71], v[172:175], v[128:131], v[68:71]
    ds_read_b64_tr_b16 v[236:237], v4 offset:0
    v_mfma_f32_16x16x32_bf16 v[68:71], v[180:183], v[132:135], v[68:71]
    v_mfma_f32_16x16x32_bf16 v[68:71], v[188:191], v[136:139], v[68:71]
    ds_read_b64_tr_b16 v[238:239], v4 offset:512
    v_mfma_f32_16x16x32_bf16 v[76:79], v[188:191], v[140:143], v[76:79]
    ds_read_b64_tr_b16 v[244:245], v4 offset:4096
    v_mfma_f32_16x16x32_bf16 v[76:79], v[180:183], v[136:139], v[76:79]
    ds_read_b64_tr_b16 v[246:247], v4 offset:4608
    v_mfma_f32_16x16x32_bf16 v[76:79], v[172:175], v[132:135], v[76:79]
    v_mfma_f32_16x16x32_bf16 v[84:87], v[172:175], v[136:139], v[84:87]
    ds_read_b64_tr_b16 v[252:253], v4 offset:8192
    v_mfma_f32_16x16x32_bf16 v[84:87], v[180:183], v[140:143], v[84:87]
    ds_read_b64_tr_b16 v[254:255], v4 offset:8704
    v_mfma_f32_16x16x32_bf16 v[84:87], v[188:191], v[144:147], v[84:87]
    ds_read_b128 v[204:207], v1 offset:480
    v_mfma_f32_16x16x32_bf16 v[92:95], v[188:191], v[148:151], v[92:95]
    v_mfma_f32_16x16x32_bf16 v[92:95], v[180:183], v[144:147], v[92:95]
    ds_read_b128 v[208:211], v1 offset:608
    v_mfma_f32_16x16x32_bf16 v[92:95], v[172:175], v[140:143], v[92:95]
    ds_read_b128 v[212:215], v1 offset:736
    v_mfma_f32_16x16x32_bf16 v[100:103], v[172:175], v[144:147], v[100:103]
    ds_read_b128 v[216:219], v1 offset:864
    v_mfma_f32_16x16x32_bf16 v[100:103], v[180:183], v[148:151], v[100:103]
    v_mfma_f32_16x16x32_bf16 v[100:103], v[188:191], v[152:155], v[100:103]
    ds_read_b128 v[220:223], v1 offset:992
    v_mfma_f32_16x16x32_bf16 v[108:111], v[188:191], v[156:159], v[108:111]
    ds_read_b128 v[224:227], v1 offset:1120
    v_mfma_f32_16x16x32_bf16 v[108:111], v[180:183], v[152:155], v[108:111]
    ds_read_b128 v[228:231], v1 offset:1280
    v_mfma_f32_16x16x32_bf16 v[108:111], v[172:175], v[148:151], v[108:111]
    v_mfma_f32_16x16x32_bf16 v[116:119], v[172:175], v[152:155], v[116:119]
    v_mfma_f32_16x16x32_bf16 v[116:119], v[180:183], v[156:159], v[116:119]
    v_mfma_f32_16x16x32_bf16 v[116:119], v[188:191], v[160:163], v[116:119]
    v_mfma_f32_16x16x32_bf16 v[124:127], v[188:191], v[164:167], v[124:127]
    v_mfma_f32_16x16x32_bf16 v[124:127], v[180:183], v[160:163], v[124:127]
    v_mfma_f32_16x16x32_bf16 v[124:127], v[172:175], v[156:159], v[124:127]
    s_waitcnt lgkmcnt(14)
    v_mfma_f32_16x16x32_bf16 v[64:67], v[232:235], v[192:195], v[64:67]
    v_mfma_f32_16x16x32_bf16 v[64:67], v[240:243], v[196:199], v[64:67]
    s_waitcnt lgkmcnt(13)
    v_mfma_f32_16x16x32_bf16 v[64:67], v[248:251], v[200:203], v[64:67]
    s_waitcnt lgkmcnt(6)
    v_mfma_f32_16x16x32_bf16 v[72:75], v[248:251], v[204:207], v[72:75]
    v_mfma_f32_16x16x32_bf16 v[72:75], v[240:243], v[200:203], v[72:75]
    v_mfma_f32_16x16x32_bf16 v[72:75], v[232:235], v[196:199], v[72:75]
    v_mfma_f32_16x16x32_bf16 v[80:83], v[232:235], v[200:203], v[80:83]
    v_mfma_f32_16x16x32_bf16 v[80:83], v[240:243], v[204:207], v[80:83]
    s_waitcnt lgkmcnt(5)
    v_mfma_f32_16x16x32_bf16 v[80:83], v[248:251], v[208:211], v[80:83]
    s_waitcnt lgkmcnt(4)
    v_mfma_f32_16x16x32_bf16 v[88:91], v[248:251], v[212:215], v[88:91]
    v_mfma_f32_16x16x32_bf16 v[88:91], v[240:243], v[208:211], v[88:91]
    v_mfma_f32_16x16x32_bf16 v[88:91], v[232:235], v[204:207], v[88:91]
    v_add_u32 v1, 4294899136, v1
    v_mfma_f32_16x16x32_bf16 v[96:99], v[232:235], v[208:211], v[96:99]
    s_waitcnt lgkmcnt(0)
    s_barrier
    v_mfma_f32_16x16x32_bf16 v[96:99], v[240:243], v[212:215], v[96:99]
    ds_read_b64_tr_b16 v[168:169], v3 offset:12288
    v_mfma_f32_16x16x32_bf16 v[96:99], v[248:251], v[216:219], v[96:99]
    ds_read_b64_tr_b16 v[170:171], v3 offset:12800
    v_mfma_f32_16x16x32_bf16 v[104:107], v[248:251], v[220:223], v[104:107]
    ds_read_b128 v[128:131], v1 offset:0
    v_mfma_f32_16x16x32_bf16 v[104:107], v[240:243], v[216:219], v[104:107]
    ds_read_b64_tr_b16 v[176:177], v3 offset:16384
    v_mfma_f32_16x16x32_bf16 v[104:107], v[232:235], v[212:215], v[104:107]
    v_mfma_f32_16x16x32_bf16 v[112:115], v[232:235], v[216:219], v[112:115]
    ds_read_b64_tr_b16 v[178:179], v3 offset:16896
    v_mfma_f32_16x16x32_bf16 v[112:115], v[240:243], v[220:223], v[112:115]
    ds_read_b128 v[132:135], v1 offset:160
    v_mfma_f32_16x16x32_bf16 v[112:115], v[248:251], v[224:227], v[112:115]
    ds_read_b64_tr_b16 v[184:185], v3 offset:20480
    v_mfma_f32_16x16x32_bf16 v[120:123], v[248:251], v[228:231], v[120:123]
    v_mfma_f32_16x16x32_bf16 v[120:123], v[240:243], v[224:227], v[120:123]
    ds_read_b64_tr_b16 v[186:187], v3 offset:20992
    v_mfma_f32_16x16x32_bf16 v[120:123], v[232:235], v[220:223], v[120:123]
    ds_read_b128 v[136:139], v1 offset:288
    v_mfma_f32_16x16x32_bf16 v[68:71], v[236:239], v[192:195], v[68:71]
    ds_read_b64_tr_b16 v[172:173], v4 offset:12288
    v_mfma_f32_16x16x32_bf16 v[68:71], v[244:247], v[196:199], v[68:71]
    v_mfma_f32_16x16x32_bf16 v[68:71], v[252:255], v[200:203], v[68:71]
    ds_read_b64_tr_b16 v[174:175], v4 offset:12800
    v_mfma_f32_16x16x32_bf16 v[76:79], v[252:255], v[204:207], v[76:79]
    ds_read_b64_tr_b16 v[180:181], v4 offset:16384
    v_mfma_f32_16x16x32_bf16 v[76:79], v[244:247], v[200:203], v[76:79]
    ds_read_b64_tr_b16 v[182:183], v4 offset:16896
    v_mfma_f32_16x16x32_bf16 v[76:79], v[236:239], v[196:199], v[76:79]
    v_mfma_f32_16x16x32_bf16 v[84:87], v[236:239], v[200:203], v[84:87]
    ds_read_b64_tr_b16 v[188:189], v4 offset:20480
    v_mfma_f32_16x16x32_bf16 v[84:87], v[244:247], v[204:207], v[84:87]
    ds_read_b64_tr_b16 v[190:191], v4 offset:20992
    v_mfma_f32_16x16x32_bf16 v[84:87], v[252:255], v[208:211], v[84:87]
    ds_read_b128 v[140:143], v1 offset:416
    v_mfma_f32_16x16x32_bf16 v[92:95], v[252:255], v[212:215], v[92:95]
    v_mfma_f32_16x16x32_bf16 v[92:95], v[244:247], v[208:211], v[92:95]
    ds_read_b128 v[144:147], v1 offset:544
    v_mfma_f32_16x16x32_bf16 v[92:95], v[236:239], v[204:207], v[92:95]
    ds_read_b128 v[148:151], v1 offset:672
    v_mfma_f32_16x16x32_bf16 v[100:103], v[236:239], v[208:211], v[100:103]
    ds_read_b128 v[152:155], v1 offset:800
    v_mfma_f32_16x16x32_bf16 v[100:103], v[244:247], v[212:215], v[100:103]
    v_mfma_f32_16x16x32_bf16 v[100:103], v[252:255], v[216:219], v[100:103]
    ds_read_b128 v[156:159], v1 offset:928
L_stub1:
    s_cbranch_scc1 L_consumer
    v_mfma_f32_16x16x32_bf16 v[108:111], v[252:255], v[220:223], v[108:111]
    ds_read_b128 v[160:163], v1 offset:1056
    v_mfma_f32_16x16x32_bf16 v[108:111], v[244:247], v[216:219], v[108:111]
    ds_read_b128 v[164:167], v1 offset:1216
    v_mfma_f32_16x16x32_bf16 v[108:111], v[236:239], v[212:215], v[108:111]
    v_mfma_f32_16x16x32_bf16 v[116:119], v[236:239], v[216:219], v[116:119]
    v_mfma_f32_16x16x32_bf16 v[116:119], v[244:247], v[220:223], v[116:119]
    v_mfma_f32_16x16x32_bf16 v[116:119], v[252:255], v[224:227], v[116:119]
    v_mfma_f32_16x16x32_bf16 v[124:127], v[252:255], v[228:231], v[124:127]
    v_mfma_f32_16x16x32_bf16 v[124:127], v[244:247], v[224:227], v[124:127]
    v_mfma_f32_16x16x32_bf16 v[124:127], v[236:239], v[220:223], v[124:127]
    s_waitcnt lgkmcnt(14)
    v_mfma_f32_16x16x32_bf16 v[64:67], v[168:171], v[128:131], v[64:67]
    s_waitcnt vmcnt(0)
    v_mfma_f32_16x16x32_bf16 v[64:67], v[176:179], v[132:135], v[64:67]
    v_lshlrev_b32 v24, 16, v24
    s_waitcnt lgkmcnt(13)
    v_mfma_f32_16x16x32_bf16 v[64:67], v[184:187], v[136:139], v[64:67]
    v_lshlrev_b32 v25, 16, v25
    s_waitcnt lgkmcnt(6)
    v_mfma_f32_16x16x32_bf16 v[72:75], v[184:187], v[140:143], v[72:75]
    v_lshlrev_b32 v26, 16, v26
    v_mfma_f32_16x16x32_bf16 v[72:75], v[176:179], v[136:139], v[72:75]
    v_lshlrev_b32 v27, 16, v27
    v_mfma_f32_16x16x32_bf16 v[72:75], v[168:171], v[132:135], v[72:75]
    v_add_f32 v25, 0x3727c5ac, v25
    v_mfma_f32_16x16x32_bf16 v[80:83], v[168:171], v[136:139], v[80:83]
    v_cvt_pk_bf16_f32 v25, v25, v25
    v_mfma_f32_16x16x32_bf16 v[80:83], v[176:179], v[140:143], v[80:83]
    v_lshlrev_b32 v25, 16, v25
    s_waitcnt lgkmcnt(5)
    v_mfma_f32_16x16x32_bf16 v[80:83], v[184:187], v[144:147], v[80:83]
    v_sqrt_f32 v25, v25
    s_waitcnt lgkmcnt(4)
    v_mfma_f32_16x16x32_bf16 v[88:91], v[184:187], v[148:151], v[88:91]
    v_cvt_pk_bf16_f32 v25, v25, v25
    v_mfma_f32_16x16x32_bf16 v[88:91], v[176:179], v[144:147], v[88:91]
    v_lshlrev_b32 v25, 16, v25
    v_mfma_f32_16x16x32_bf16 v[88:91], v[168:171], v[140:143], v[88:91]
    v_rcp_f32 v25, v25
    v_mfma_f32_16x16x32_bf16 v[96:99], v[168:171], v[144:147], v[96:99]
    s_waitcnt lgkmcnt(0)
    s_barrier
    v_mfma_f32_16x16x32_bf16 v[96:99], v[176:179], v[148:151], v[96:99]
    ds_read_b64_tr_b16 v[232:233], v3 offset:24576
    v_mfma_f32_16x16x32_bf16 v[96:99], v[184:187], v[152:155], v[96:99]
    ds_read_b64_tr_b16 v[234:235], v3 offset:25088
    v_mfma_f32_16x16x32_bf16 v[104:107], v[184:187], v[156:159], v[104:107]
    ds_read_b128 v[192:195], v1 offset:64
    v_mfma_f32_16x16x32_bf16 v[104:107], v[176:179], v[152:155], v[104:107]
    ds_read_b64_tr_b16 v[240:241], v3 offset:28672
    v_mfma_f32_16x16x32_bf16 v[104:107], v[168:171], v[148:151], v[104:107]
    v_cvt_pk_bf16_f32 v25, v25, v25
    v_mfma_f32_16x16x32_bf16 v[112:115], v[168:171], v[152:155], v[112:115]
    ds_read_b64_tr_b16 v[242:243], v3 offset:29184
    v_mfma_f32_16x16x32_bf16 v[112:115], v[176:179], v[156:159], v[112:115]
    ds_read_b128 v[196:199], v1 offset:224
    v_mfma_f32_16x16x32_bf16 v[112:115], v[184:187], v[160:163], v[112:115]
    ds_read_b64_tr_b16 v[248:249], v3 offset:32768
    v_mfma_f32_16x16x32_bf16 v[120:123], v[184:187], v[164:167], v[120:123]
    v_lshlrev_b32 v25, 16, v25
    v_mfma_f32_16x16x32_bf16 v[120:123], v[176:179], v[160:163], v[120:123]
    ds_read_b64_tr_b16 v[250:251], v3 offset:33280
    v_mfma_f32_16x16x32_bf16 v[120:123], v[168:171], v[156:159], v[120:123]
    ds_read_b128 v[200:203], v1 offset:352
    v_mfma_f32_16x16x32_bf16 v[68:71], v[172:175], v[128:131], v[68:71]
    ds_read_b64_tr_b16 v[236:237], v4 offset:24576
    v_mfma_f32_16x16x32_bf16 v[68:71], v[180:183], v[132:135], v[68:71]
    v_mul_f32 v25, v26, v25
    v_mfma_f32_16x16x32_bf16 v[68:71], v[188:191], v[136:139], v[68:71]
    ds_read_b64_tr_b16 v[238:239], v4 offset:25088
    v_mfma_f32_16x16x32_bf16 v[76:79], v[188:191], v[140:143], v[76:79]
    ds_read_b64_tr_b16 v[244:245], v4 offset:28672
    v_mfma_f32_16x16x32_bf16 v[76:79], v[180:183], v[136:139], v[76:79]
    ds_read_b64_tr_b16 v[246:247], v4 offset:29184
    v_mfma_f32_16x16x32_bf16 v[76:79], v[172:175], v[132:135], v[76:79]
    v_cvt_pk_bf16_f32 v25, v25, v25
    v_mfma_f32_16x16x32_bf16 v[84:87], v[172:175], v[136:139], v[84:87]
    ds_read_b64_tr_b16 v[252:253], v4 offset:32768
    v_mfma_f32_16x16x32_bf16 v[84:87], v[180:183], v[140:143], v[84:87]
    ds_read_b64_tr_b16 v[254:255], v4 offset:33280
    v_mfma_f32_16x16x32_bf16 v[84:87], v[188:191], v[144:147], v[84:87]
    ds_read_b128 v[204:207], v1 offset:480
    v_mfma_f32_16x16x32_bf16 v[92:95], v[188:191], v[148:151], v[92:95]
    v_lshlrev_b32 v25, 16, v25
    v_mfma_f32_16x16x32_bf16 v[92:95], v[180:183], v[144:147], v[92:95]
    ds_read_b128 v[208:211], v1 offset:608
    v_mfma_f32_16x16x32_bf16 v[92:95], v[172:175], v[140:143], v[92:95]
    ds_read_b128 v[212:215], v1 offset:736
    v_mfma_f32_16x16x32_bf16 v[100:103], v[172:175], v[144:147], v[100:103]
    ds_read_b128 v[216:219], v1 offset:864
    v_mfma_f32_16x16x32_bf16 v[100:103], v[180:183], v[148:151], v[100:103]
    v_fma_f32 v27, -v24, v25, v27
    v_mfma_f32_16x16x32_bf16 v[100:103], v[188:191], v[152:155], v[100:103]
    ds_read_b128 v[220:223], v1 offset:992
    v_mfma_f32_16x16x32_bf16 v[108:111], v[188:191], v[156:159], v[108:111]
    ds_read_b128 v[224:227], v1 offset:1120
    v_mfma_f32_16x16x32_bf16 v[108:111], v[180:183], v[152:155], v[108:111]
    ds_read_b128 v[228:231], v1 offset:1280
    v_mfma_f32_16x16x32_bf16 v[108:111], v[172:175], v[148:151], v[108:111]
    v_mul_f32 v25, 0xbfb8aa3b, v25
    v_mfma_f32_16x16x32_bf16 v[116:119], v[172:175], v[152:155], v[116:119]
    v_mul_f32 v27, 0xbfb8aa3b, v27
    v_mfma_f32_16x16x32_bf16 v[116:119], v[180:183], v[156:159], v[116:119]
    v_mfma_f32_16x16x32_bf16 v[116:119], v[188:191], v[160:163], v[116:119]
    v_mfma_f32_16x16x32_bf16 v[124:127], v[188:191], v[164:167], v[124:127]
    v_mfma_f32_16x16x32_bf16 v[124:127], v[180:183], v[160:163], v[124:127]
    v_mfma_f32_16x16x32_bf16 v[124:127], v[172:175], v[156:159], v[124:127]
    s_waitcnt lgkmcnt(14)
    v_mfma_f32_16x16x32_bf16 v[64:67], v[232:235], v[192:195], v[64:67]
    v_mfma_f32_16x16x32_bf16 v[64:67], v[240:243], v[196:199], v[64:67]
    s_waitcnt lgkmcnt(13)
    v_mfma_f32_16x16x32_bf16 v[64:67], v[248:251], v[200:203], v[64:67]
    s_waitcnt lgkmcnt(6)
    v_mfma_f32_16x16x32_bf16 v[72:75], v[248:251], v[204:207], v[72:75]
    v_mfma_f32_16x16x32_bf16 v[72:75], v[240:243], v[200:203], v[72:75]
    v_mfma_f32_16x16x32_bf16 v[72:75], v[232:235], v[196:199], v[72:75]
    v_mfma_f32_16x16x32_bf16 v[80:83], v[232:235], v[200:203], v[80:83]
    v_mfma_f32_16x16x32_bf16 v[80:83], v[240:243], v[204:207], v[80:83]
    s_waitcnt lgkmcnt(5)
    v_mfma_f32_16x16x32_bf16 v[80:83], v[248:251], v[208:211], v[80:83]
    s_waitcnt lgkmcnt(4)
    v_mfma_f32_16x16x32_bf16 v[88:91], v[248:251], v[212:215], v[88:91]
    v_mfma_f32_16x16x32_bf16 v[88:91], v[240:243], v[208:211], v[88:91]
    v_mfma_f32_16x16x32_bf16 v[88:91], v[232:235], v[204:207], v[88:91]
    v_add_u32 v1, 34080, v1
    v_mfma_f32_16x16x32_bf16 v[96:99], v[232:235], v[208:211], v[96:99]
    s_waitcnt lgkmcnt(0)
    s_barrier
    v_mfma_f32_16x16x32_bf16 v[96:99], v[240:243], v[212:215], v[96:99]
    ds_read_b64_tr_b16 v[168:169], v3 offset:36864
    v_mfma_f32_16x16x32_bf16 v[96:99], v[248:251], v[216:219], v[96:99]
    ds_read_b64_tr_b16 v[170:171], v3 offset:37376
    v_mfma_f32_16x16x32_bf16 v[104:107], v[248:251], v[220:223], v[104:107]
    ds_read_b128 v[128:131], v1 offset:0
    v_mfma_f32_16x16x32_bf16 v[104:107], v[240:243], v[216:219], v[104:107]
    ds_read_b64_tr_b16 v[176:177], v3 offset:40960
    v_mfma_f32_16x16x32_bf16 v[104:107], v[232:235], v[212:215], v[104:107]
    v_mfma_f32_16x16x32_bf16 v[112:115], v[232:235], v[216:219], v[112:115]
    ds_read_b64_tr_b16 v[178:179], v3 offset:41472
    v_mfma_f32_16x16x32_bf16 v[112:115], v[240:243], v[220:223], v[112:115]
    ds_read_b128 v[132:135], v1 offset:160
    v_mfma_f32_16x16x32_bf16 v[112:115], v[248:251], v[224:227], v[112:115]
    ds_read_b64_tr_b16 v[184:185], v3 offset:45056
    v_mfma_f32_16x16x32_bf16 v[120:123], v[248:251], v[228:231], v[120:123]
    v_mfma_f32_16x16x32_bf16 v[120:123], v[240:243], v[224:227], v[120:123]
    ds_read_b64_tr_b16 v[186:187], v3 offset:45568
    v_mfma_f32_16x16x32_bf16 v[120:123], v[232:235], v[220:223], v[120:123]
    ds_read_b128 v[136:139], v1 offset:288
    v_mfma_f32_16x16x32_bf16 v[68:71], v[236:239], v[192:195], v[68:71]
    ds_read_b64_tr_b16 v[172:173], v4 offset:36864
    v_mfma_f32_16x16x32_bf16 v[68:71], v[244:247], v[196:199], v[68:71]
    v_mfma_f32_16x16x32_bf16 v[68:71], v[252:255], v[200:203], v[68:71]
    ds_read_b64_tr_b16 v[174:175], v4 offset:37376
    v_mfma_f32_16x16x32_bf16 v[76:79], v[252:255], v[204:207], v[76:79]
    ds_read_b64_tr_b16 v[180:181], v4 offset:40960
    v_mfma_f32_16x16x32_bf16 v[76:79], v[244:247], v[200:203], v[76:79]
    ds_read_b64_tr_b16 v[182:183], v4 offset:41472
    v_mfma_f32_16x16x32_bf16 v[76:79], v[236:239], v[196:199], v[76:79]
    v_mfma_f32_16x16x32_bf16 v[84:87], v[236:239], v[200:203], v[84:87]
    ds_read_b64_tr_b16 v[188:189], v4 offset:45056
    v_mfma_f32_16x16x32_bf16 v[84:87], v[244:247], v[204:207], v[84:87]
    ds_read_b64_tr_b16 v[190:191], v4 offset:45568
    v_mfma_f32_16x16x32_bf16 v[84:87], v[252:255], v[208:211], v[84:87]
    ds_read_b128 v[140:143], v1 offset:416
    v_mfma_f32_16x16x32_bf16 v[92:95], v[252:255], v[212:215], v[92:95]
    v_mfma_f32_16x16x32_bf16 v[92:95], v[244:247], v[208:211], v[92:95]
    ds_read_b128 v[144:147], v1 offset:544
    v_mfma_f32_16x16x32_bf16 v[92:95], v[236:239], v[204:207], v[92:95]
    ds_read_b128 v[148:151], v1 offset:672
    v_mfma_f32_16x16x32_bf16 v[100:103], v[236:239], v[208:211], v[100:103]
    ds_read_b128 v[152:155], v1 offset:800
    v_mfma_f32_16x16x32_bf16 v[100:103], v[244:247], v[212:215], v[100:103]
    v_mfma_f32_16x16x32_bf16 v[100:103], v[252:255], v[216:219], v[100:103]
    ds_read_b128 v[156:159], v1 offset:928
    v_mfma_f32_16x16x32_bf16 v[108:111], v[252:255], v[220:223], v[108:111]
    ds_read_b128 v[160:163], v1 offset:1056
    v_mfma_f32_16x16x32_bf16 v[108:111], v[244:247], v[216:219], v[108:111]
    ds_read_b128 v[164:167], v1 offset:1216
    v_mfma_f32_16x16x32_bf16 v[108:111], v[236:239], v[212:215], v[108:111]
    v_mfma_f32_16x16x32_bf16 v[116:119], v[236:239], v[216:219], v[116:119]
    v_mfma_f32_16x16x32_bf16 v[116:119], v[244:247], v[220:223], v[116:119]
    v_mfma_f32_16x16x32_bf16 v[116:119], v[252:255], v[224:227], v[116:119]
    v_mfma_f32_16x16x32_bf16 v[124:127], v[252:255], v[228:231], v[124:127]
    v_mfma_f32_16x16x32_bf16 v[124:127], v[244:247], v[224:227], v[124:127]
    v_mfma_f32_16x16x32_bf16 v[124:127], v[236:239], v[220:223], v[124:127]
    s_waitcnt lgkmcnt(14)
    v_mfma_f32_16x16x32_bf16 v[64:67], v[168:171], v[128:131], v[64:67]
    v_mfma_f32_16x16x32_bf16 v[64:67], v[176:179], v[132:135], v[64:67]
    s_waitcnt lgkmcnt(13)
    v_mfma_f32_16x16x32_bf16 v[64:67], v[184:187], v[136:139], v[64:67]
    s_waitcnt lgkmcnt(6)
    v_mfma_f32_16x16x32_bf16 v[72:75], v[184:187], v[140:143], v[72:75]
    v_mfma_f32_16x16x32_bf16 v[72:75], v[176:179], v[136:139], v[72:75]
    v_mfma_f32_16x16x32_bf16 v[72:75], v[168:171], v[132:135], v[72:75]
    v_mfma_f32_16x16x32_bf16 v[80:83], v[168:171], v[136:139], v[80:83]
    v_mfma_f32_16x16x32_bf16 v[80:83], v[176:179], v[140:143], v[80:83]
    s_waitcnt lgkmcnt(5)
    v_mfma_f32_16x16x32_bf16 v[80:83], v[184:187], v[144:147], v[80:83]
    s_waitcnt lgkmcnt(4)
    v_mfma_f32_16x16x32_bf16 v[88:91], v[184:187], v[148:151], v[88:91]
    v_mfma_f32_16x16x32_bf16 v[88:91], v[176:179], v[144:147], v[88:91]
    v_mfma_f32_16x16x32_bf16 v[88:91], v[168:171], v[140:143], v[88:91]
    v_mfma_f32_16x16x32_bf16 v[96:99], v[168:171], v[144:147], v[96:99]
    s_waitcnt lgkmcnt(0)
    s_barrier
    v_mfma_f32_16x16x32_bf16 v[96:99], v[176:179], v[148:151], v[96:99]
    ds_read_b64_tr_b16 v[232:233], v3 offset:49152
    v_mfma_f32_16x16x32_bf16 v[96:99], v[184:187], v[152:155], v[96:99]
    ds_read_b64_tr_b16 v[234:235], v3 offset:49664
    v_mfma_f32_16x16x32_bf16 v[104:107], v[184:187], v[156:159], v[104:107]
    ds_read_b128 v[192:195], v1 offset:64
    v_mfma_f32_16x16x32_bf16 v[104:107], v[176:179], v[152:155], v[104:107]
    ds_read_b64_tr_b16 v[240:241], v3 offset:53248
    v_mfma_f32_16x16x32_bf16 v[104:107], v[168:171], v[148:151], v[104:107]
    v_mfma_f32_16x16x32_bf16 v[112:115], v[168:171], v[152:155], v[112:115]
    ds_read_b64_tr_b16 v[242:243], v3 offset:53760
    v_mfma_f32_16x16x32_bf16 v[112:115], v[176:179], v[156:159], v[112:115]
    ds_read_b128 v[196:199], v1 offset:224
    v_mfma_f32_16x16x32_bf16 v[112:115], v[184:187], v[160:163], v[112:115]
    ds_read_b64_tr_b16 v[248:249], v3 offset:57344
    v_mfma_f32_16x16x32_bf16 v[120:123], v[184:187], v[164:167], v[120:123]
    v_mfma_f32_16x16x32_bf16 v[120:123], v[176:179], v[160:163], v[120:123]
    ds_read_b64_tr_b16 v[250:251], v3 offset:57856
    v_mfma_f32_16x16x32_bf16 v[120:123], v[168:171], v[156:159], v[120:123]
    ds_read_b128 v[200:203], v1 offset:352
    v_mfma_f32_16x16x32_bf16 v[68:71], v[172:175], v[128:131], v[68:71]
    ds_read_b64_tr_b16 v[236:237], v4 offset:49152
    v_mfma_f32_16x16x32_bf16 v[68:71], v[180:183], v[132:135], v[68:71]
    v_mfma_f32_16x16x32_bf16 v[68:71], v[188:191], v[136:139], v[68:71]
    ds_read_b64_tr_b16 v[238:239], v4 offset:49664
    v_mfma_f32_16x16x32_bf16 v[76:79], v[188:191], v[140:143], v[76:79]
    ds_read_b64_tr_b16 v[244:245], v4 offset:53248
    v_mfma_f32_16x16x32_bf16 v[76:79], v[180:183], v[136:139], v[76:79]
    ds_read_b64_tr_b16 v[246:247], v4 offset:53760
    v_mfma_f32_16x16x32_bf16 v[76:79], v[172:175], v[132:135], v[76:79]
    v_mfma_f32_16x16x32_bf16 v[84:87], v[172:175], v[136:139], v[84:87]
    ds_read_b64_tr_b16 v[252:253], v4 offset:57344
    v_mfma_f32_16x16x32_bf16 v[84:87], v[180:183], v[140:143], v[84:87]
    ds_read_b64_tr_b16 v[254:255], v4 offset:57856
    v_mfma_f32_16x16x32_bf16 v[84:87], v[188:191], v[144:147], v[84:87]
    ds_read_b128 v[204:207], v1 offset:480
    v_mfma_f32_16x16x32_bf16 v[92:95], v[188:191], v[148:151], v[92:95]
    v_mfma_f32_16x16x32_bf16 v[92:95], v[180:183], v[144:147], v[92:95]
    ds_read_b128 v[208:211], v1 offset:608
    v_mfma_f32_16x16x32_bf16 v[92:95], v[172:175], v[140:143], v[92:95]
    ds_read_b128 v[212:215], v1 offset:736
    v_mfma_f32_16x16x32_bf16 v[100:103], v[172:175], v[144:147], v[100:103]
    ds_read_b128 v[216:219], v1 offset:864
    v_mfma_f32_16x16x32_bf16 v[100:103], v[180:183], v[148:151], v[100:103]
    v_mfma_f32_16x16x32_bf16 v[100:103], v[188:191], v[152:155], v[100:103]
    ds_read_b128 v[220:223], v1 offset:992
    v_mfma_f32_16x16x32_bf16 v[108:111], v[188:191], v[156:159], v[108:111]
    ds_read_b128 v[224:227], v1 offset:1120
    v_mfma_f32_16x16x32_bf16 v[108:111], v[180:183], v[152:155], v[108:111]
    ds_read_b128 v[228:231], v1 offset:1280
    v_mfma_f32_16x16x32_bf16 v[108:111], v[172:175], v[148:151], v[108:111]
    v_mfma_f32_16x16x32_bf16 v[116:119], v[172:175], v[152:155], v[116:119]
    v_mfma_f32_16x16x32_bf16 v[116:119], v[180:183], v[156:159], v[116:119]
    v_mfma_f32_16x16x32_bf16 v[116:119], v[188:191], v[160:163], v[116:119]
    v_mfma_f32_16x16x32_bf16 v[124:127], v[188:191], v[164:167], v[124:127]
    v_mfma_f32_16x16x32_bf16 v[124:127], v[180:183], v[160:163], v[124:127]
    v_mfma_f32_16x16x32_bf16 v[124:127], v[172:175], v[156:159], v[124:127]
    s_waitcnt lgkmcnt(14)
    v_mfma_f32_16x16x32_bf16 v[64:67], v[232:235], v[192:195], v[64:67]
    v_add_u32 v1, 34080, v1
    v_mfma_f32_16x16x32_bf16 v[64:67], v[240:243], v[196:199], v[64:67]
    s_waitcnt lgkmcnt(0)
    s_barrier
    v_mfma_f32_16x16x32_bf16 v[64:67], v[248:251], v[200:203], v[64:67]
    ds_read_b64_tr_b16 v[128:129], v3 offset:0
    v_mfma_f32_16x16x32_bf16 v[68:71], v[236:239], v[192:195], v[68:71]
    ds_read_b64_tr_b16 v[130:131], v3 offset:512
    v_mfma_f32_16x16x32_bf16 v[68:71], v[244:247], v[196:199], v[68:71]
    ds_read_b128 v[32:35], v1 offset:0
    v_mfma_f32_16x16x32_bf16 v[68:71], v[252:255], v[200:203], v[68:71]
    ds_read_b64_tr_b16 v[136:137], v3 offset:4096
    v_mfma_f32_16x16x32_bf16 v[72:75], v[232:235], v[196:199], v[72:75]
    ds_read_b64_tr_b16 v[138:139], v3 offset:4608
    v_mfma_f32_16x16x32_bf16 v[72:75], v[240:243], v[200:203], v[72:75]
    ds_read_b128 v[36:39], v1 offset:160
    v_mfma_f32_16x16x32_bf16 v[72:75], v[248:251], v[204:207], v[72:75]
    ds_read_b64_tr_b16 v[144:145], v3 offset:8192
    v_mfma_f32_16x16x32_bf16 v[76:79], v[236:239], v[196:199], v[76:79]
    ds_read_b64_tr_b16 v[146:147], v3 offset:8704
    v_mfma_f32_16x16x32_bf16 v[76:79], v[244:247], v[200:203], v[76:79]
    ds_read_b128 v[40:43], v1 offset:288
    v_mfma_f32_16x16x32_bf16 v[76:79], v[252:255], v[204:207], v[76:79]
    ds_read_b64_tr_b16 v[132:133], v4 offset:0
    v_mfma_f32_16x16x32_bf16 v[80:83], v[232:235], v[200:203], v[80:83]
    ds_read_b64_tr_b16 v[134:135], v4 offset:512
    v_mfma_f32_16x16x32_bf16 v[80:83], v[240:243], v[204:207], v[80:83]
    ds_read_b64_tr_b16 v[140:141], v4 offset:4096
    v_mfma_f32_16x16x32_bf16 v[80:83], v[248:251], v[208:211], v[80:83]
    ds_read_b64_tr_b16 v[142:143], v4 offset:4608
    v_mfma_f32_16x16x32_bf16 v[84:87], v[236:239], v[200:203], v[84:87]
    ds_read_b64_tr_b16 v[148:149], v4 offset:8192
    v_mfma_f32_16x16x32_bf16 v[84:87], v[244:247], v[204:207], v[84:87]
    ds_read_b64_tr_b16 v[150:151], v4 offset:8704
    v_mfma_f32_16x16x32_bf16 v[84:87], v[252:255], v[208:211], v[84:87]
    ds_read_b128 v[44:47], v1 offset:416
    v_mfma_f32_16x16x32_bf16 v[88:91], v[232:235], v[204:207], v[88:91]
    s_barrier
    ds_read_b64_tr_b16 v[152:153], v3 offset:12288
    v_mfma_f32_16x16x32_bf16 v[88:91], v[240:243], v[208:211], v[88:91]
    ds_read_b64_tr_b16 v[154:155], v3 offset:12800
    v_mfma_f32_16x16x32_bf16 v[88:91], v[248:251], v[212:215], v[88:91]
    ds_read_b128 v[48:51], v1 offset:64
    v_mfma_f32_16x16x32_bf16 v[92:95], v[236:239], v[204:207], v[92:95]
    ds_read_b64_tr_b16 v[160:161], v3 offset:16384
    v_mfma_f32_16x16x32_bf16 v[92:95], v[244:247], v[208:211], v[92:95]
    ds_read_b64_tr_b16 v[162:163], v3 offset:16896
    v_mfma_f32_16x16x32_bf16 v[92:95], v[252:255], v[212:215], v[92:95]
    ds_read_b128 v[52:55], v1 offset:224
    v_mfma_f32_16x16x32_bf16 v[96:99], v[232:235], v[208:211], v[96:99]
    ds_read_b64_tr_b16 v[168:169], v3 offset:20480
    v_mfma_f32_16x16x32_bf16 v[96:99], v[240:243], v[212:215], v[96:99]
    ds_read_b64_tr_b16 v[170:171], v3 offset:20992
    v_mfma_f32_16x16x32_bf16 v[96:99], v[248:251], v[216:219], v[96:99]
    ds_read_b128 v[56:59], v1 offset:352
    v_mfma_f32_16x16x32_bf16 v[100:103], v[236:239], v[208:211], v[100:103]
    ds_read_b64_tr_b16 v[156:157], v4 offset:12288
    v_mfma_f32_16x16x32_bf16 v[100:103], v[244:247], v[212:215], v[100:103]
    ds_read_b64_tr_b16 v[158:159], v4 offset:12800
    v_mfma_f32_16x16x32_bf16 v[100:103], v[252:255], v[216:219], v[100:103]
    ds_read_b64_tr_b16 v[164:165], v4 offset:16384
    v_mfma_f32_16x16x32_bf16 v[104:107], v[232:235], v[212:215], v[104:107]
    ds_read_b64_tr_b16 v[166:167], v4 offset:16896
    v_mfma_f32_16x16x32_bf16 v[104:107], v[240:243], v[216:219], v[104:107]
    ds_read_b64_tr_b16 v[172:173], v4 offset:20480
    v_mfma_f32_16x16x32_bf16 v[104:107], v[248:251], v[220:223], v[104:107]
    ds_read_b64_tr_b16 v[174:175], v4 offset:20992
    v_mfma_f32_16x16x32_bf16 v[108:111], v[236:239], v[212:215], v[108:111]
    ds_read_b128 v[60:63], v1 offset:480
    v_mfma_f32_16x16x32_bf16 v[108:111], v[244:247], v[216:219], v[108:111]
    ds_write_b32 v28, v25 offset:0
    v_mfma_f32_16x16x32_bf16 v[108:111], v[252:255], v[220:223], v[108:111]
    s_barrier
    ds_write_b32 v28, v27 offset:8448
    v_mfma_f32_16x16x32_bf16 v[112:115], v[232:235], v[216:219], v[112:115]
    ds_read_b64_tr_b16 v[192:193], v3 offset:24576
    v_mfma_f32_16x16x32_bf16 v[112:115], v[240:243], v[220:223], v[112:115]
    ds_read_b64_tr_b16 v[194:195], v3 offset:25088
    v_mfma_f32_16x16x32_bf16 v[112:115], v[248:251], v[224:227], v[112:115]
    ds_read_b128 v[176:179], v2 offset:0
    v_mfma_f32_16x16x32_bf16 v[116:119], v[236:239], v[216:219], v[116:119]
    ds_read_b64_tr_b16 v[200:201], v3 offset:28672
    v_mfma_f32_16x16x32_bf16 v[116:119], v[244:247], v[220:223], v[116:119]
    ds_read_b64_tr_b16 v[202:203], v3 offset:29184
    v_mfma_f32_16x16x32_bf16 v[116:119], v[252:255], v[224:227], v[116:119]
    ds_read_b128 v[180:183], v2 offset:160
    v_mfma_f32_16x16x32_bf16 v[120:123], v[232:235], v[220:223], v[120:123]
    ds_read_b64_tr_b16 v[208:209], v3 offset:32768
    v_mfma_f32_16x16x32_bf16 v[120:123], v[240:243], v[224:227], v[120:123]
    ds_read_b64_tr_b16 v[210:211], v3 offset:33280
    v_mfma_f32_16x16x32_bf16 v[120:123], v[248:251], v[228:231], v[120:123]
    ds_read_b128 v[184:187], v2 offset:288
    v_mfma_f32_16x16x32_bf16 v[124:127], v[236:239], v[220:223], v[124:127]
    ds_read_b64_tr_b16 v[196:197], v4 offset:24576
    v_mfma_f32_16x16x32_bf16 v[124:127], v[244:247], v[224:227], v[124:127]
    ds_read_b64_tr_b16 v[198:199], v4 offset:25088
    v_mfma_f32_16x16x32_bf16 v[124:127], v[252:255], v[228:231], v[124:127]
    ds_read_b64_tr_b16 v[204:205], v4 offset:28672
    s_waitcnt lgkmcnt(14)
    v_mfma_f32_16x16x32_bf16 v[64:67], v[128:131], v[32:35], v[64:67]
    ds_read_b64_tr_b16 v[206:207], v4 offset:29184
    v_mfma_f32_16x16x32_bf16 v[64:67], v[136:139], v[36:39], v[64:67]
    ds_read_b64_tr_b16 v[212:213], v4 offset:32768
    v_mfma_f32_16x16x32_bf16 v[64:67], v[144:147], v[40:43], v[64:67]
    ds_read_b64_tr_b16 v[214:215], v4 offset:33280
    v_mfma_f32_16x16x32_bf16 v[68:71], v[132:135], v[32:35], v[68:71]
    ds_read_b128 v[188:191], v2 offset:416
    s_barrier
    v_mfma_f32_16x16x32_bf16 v[68:71], v[140:143], v[36:39], v[68:71]
    ds_read_b64_tr_b16 v[216:217], v3 offset:36864
    v_mfma_f32_16x16x32_bf16 v[68:71], v[148:151], v[40:43], v[68:71]
    ds_read_b64_tr_b16 v[218:219], v3 offset:37376
    v_mfma_f32_16x16x32_bf16 v[64:67], v[152:155], v[48:51], v[64:67]
    ds_read_b128 v[240:243], v2 offset:64
    v_mfma_f32_16x16x32_bf16 v[64:67], v[160:163], v[52:55], v[64:67]
    ds_read_b64_tr_b16 v[224:225], v3 offset:40960
    v_mfma_f32_16x16x32_bf16 v[64:67], v[168:171], v[56:59], v[64:67]
    ds_read_b64_tr_b16 v[226:227], v3 offset:41472
    v_mfma_f32_16x16x32_bf16 v[68:71], v[156:159], v[48:51], v[68:71]
    ds_read_b128 v[244:247], v2 offset:224
    v_mfma_f32_16x16x32_bf16 v[68:71], v[164:167], v[52:55], v[68:71]
    ds_read_b64_tr_b16 v[232:233], v3 offset:45056
    v_mfma_f32_16x16x32_bf16 v[68:71], v[172:175], v[56:59], v[68:71]
    ds_read_b64_tr_b16 v[234:235], v3 offset:45568
    v_mfma_f32_16x16x32_bf16 v[72:75], v[128:131], v[36:39], v[72:75]
    ds_read_b128 v[248:251], v2 offset:352
    v_mfma_f32_16x16x32_bf16 v[72:75], v[136:139], v[40:43], v[72:75]
    ds_read_b64_tr_b16 v[220:221], v4 offset:36864
    v_mfma_f32_16x16x32_bf16 v[72:75], v[144:147], v[44:47], v[72:75]
    ds_read_b64_tr_b16 v[222:223], v4 offset:37376
    v_mfma_f32_16x16x32_bf16 v[76:79], v[132:135], v[36:39], v[76:79]
    ds_read_b64_tr_b16 v[228:229], v4 offset:40960
    v_mfma_f32_16x16x32_bf16 v[76:79], v[140:143], v[40:43], v[76:79]
    ds_read_b64_tr_b16 v[230:231], v4 offset:41472
    v_mfma_f32_16x16x32_bf16 v[76:79], v[148:151], v[44:47], v[76:79]
    ds_read_b64_tr_b16 v[236:237], v4 offset:45056
    s_waitcnt lgkmcnt(14)
    v_mfma_f32_16x16x32_bf16 v[64:67], v[192:195], v[176:179], v[64:67]
    ds_read_b64_tr_b16 v[238:239], v4 offset:45568
    v_mfma_f32_16x16x32_bf16 v[64:67], v[200:203], v[180:183], v[64:67]
    ds_read_b128 v[252:255], v2 offset:480
    v_mfma_f32_16x16x32_bf16 v[64:67], v[208:211], v[184:187], v[64:67]
    ds_read_b128 v[16:19], v6 offset:0
    v_mfma_f32_16x16x32_bf16 v[68:71], v[196:199], v[176:179], v[68:71]
    ds_read_b128 v[24:27], v6 offset:8448
    v_mfma_f32_16x16x32_bf16 v[68:71], v[204:207], v[180:183], v[68:71]
    ds_read_b128 v[20:23], v6 offset:2112
    v_mfma_f32_16x16x32_bf16 v[68:71], v[212:215], v[184:187], v[68:71]
    ds_read_b128 v[28:31], v6 offset:10560
    s_waitcnt lgkmcnt(14)
    v_mfma_f32_16x16x32_bf16 v[64:67], v[216:219], v[240:243], v[64:67]
    ds_read_b128 v[32:35], v1 offset:544
    v_mfma_f32_16x16x32_bf16 v[64:67], v[224:227], v[244:247], v[64:67]
    ds_read_b128 v[48:51], v1 offset:608
    s_waitcnt lgkmcnt(13)
    v_mfma_f32_16x16x32_bf16 v[64:67], v[232:235], v[248:251], v[64:67]
    ds_read_b128 v[176:179], v2 offset:544
    s_waitcnt lgkmcnt(12)
    v_mfma_f32_16x16x32_bf16 v[68:71], v[220:223], v[240:243], v[68:71]
    ds_read_b128 v[36:39], v1 offset:672
    s_waitcnt lgkmcnt(11)
    v_mfma_f32_16x16x32_bf16 v[68:71], v[228:231], v[244:247], v[68:71]
    s_waitcnt lgkmcnt(9)
    v_mfma_f32_16x16x32_bf16 v[68:71], v[236:239], v[248:251], v[68:71]
    ds_read_b128 v[240:243], v2 offset:608
    v_mfma_f32_16x16x32_bf16 v[72:75], v[152:155], v[52:55], v[72:75]
    v_mfma_f32_16x16x32_bf16 v[72:75], v[160:163], v[56:59], v[72:75]
    v_mfma_f32_16x16x32_bf16 v[72:75], v[168:171], v[60:63], v[72:75]
    v_mfma_f32_16x16x32_bf16 v[72:75], v[192:195], v[180:183], v[72:75]
    s_waitcnt lgkmcnt(0)
    v_mfma_f32_16x16x32_bf16 v[72:75], v[200:203], v[184:187], v[72:75]
    v_fma_f32 v64, v64, v16, v24
    v_fma_f32 v65, v65, v17, v25
    v_mfma_f32_16x16x32_bf16 v[72:75], v[208:211], v[188:191], v[72:75]
    v_exp_f32 v8, v64
    v_mfma_f32_16x16x32_bf16 v[72:75], v[216:219], v[244:247], v[72:75]
    v_exp_f32 v9, v65
    v_mfma_f32_16x16x32_bf16 v[72:75], v[224:227], v[248:251], v[72:75]
    v_fma_f32 v8, v8, s44, s44
    v_fma_f32 v66, v66, v18, v26
    v_mfma_f32_16x16x32_bf16 v[72:75], v[232:235], v[252:255], v[72:75]
    v_rcp_f32 v8, v8
    v_mfma_f32_16x16x32_bf16 v[76:79], v[156:159], v[52:55], v[76:79]
    v_fma_f32 v9, v9, s44, s44
    v_fma_f32 v67, v67, v19, v27
    v_mfma_f32_16x16x32_bf16 v[76:79], v[164:167], v[56:59], v[76:79]
    v_mul_f32 v64, v64, v8
    v_fma_f32 v68, v68, v20, v28
    v_mfma_f32_16x16x32_bf16 v[76:79], v[172:175], v[60:63], v[76:79]
    ds_read_b128 v[52:55], v1 offset:736
    v_fma_f32 v69, v69, v21, v29
    v_mfma_f32_16x16x32_bf16 v[76:79], v[196:199], v[180:183], v[76:79]
    v_rcp_f32 v9, v9
    v_mfma_f32_16x16x32_bf16 v[76:79], v[204:207], v[184:187], v[76:79]
    v_exp_f32 v10, v66
    v_mfma_f32_16x16x32_bf16 v[76:79], v[212:215], v[188:191], v[76:79]
    ds_read_b128 v[180:183], v2 offset:672
    v_mul_f32 v65, v65, v9
    v_mfma_f32_16x16x32_bf16 v[76:79], v[220:223], v[244:247], v[76:79]
    v_fma_f32 v10, v10, s44, s44
    v_fma_f32 v70, v70, v22, v30
    v_mfma_f32_16x16x32_bf16 v[76:79], v[228:231], v[248:251], v[76:79]
    v_rcp_f32 v10, v10
    v_mfma_f32_16x16x32_bf16 v[76:79], v[236:239], v[252:255], v[76:79]
    ds_read_b128 v[244:247], v2 offset:736
    v_fma_f32 v71, v71, v23, v31
    v_mfma_f32_16x16x32_bf16 v[80:83], v[128:131], v[40:43], v[80:83]
    v_mul_f32 v66, v66, v10
    v_cvt_pk_bf16_f32 v64, v64, v65
    v_mfma_f32_16x16x32_bf16 v[80:83], v[136:139], v[44:47], v[80:83]
    v_exp_f32 v11, v67
    v_mfma_f32_16x16x32_bf16 v[80:83], v[144:147], v[32:35], v[80:83]
    v_exp_f32 v12, v68
    v_mfma_f32_16x16x32_bf16 v[80:83], v[152:155], v[56:59], v[80:83]
    v_fma_f32 v11, v11, s44, s44
    v_fma_f32 v72, v72, v16, v24
    v_mfma_f32_16x16x32_bf16 v[80:83], v[160:163], v[60:63], v[80:83]
    v_rcp_f32 v11, v11
    v_mfma_f32_16x16x32_bf16 v[80:83], v[168:171], v[48:51], v[80:83]
    v_fma_f32 v12, v12, s44, s44
    v_fma_f32 v73, v73, v17, v25
    v_mfma_f32_16x16x32_bf16 v[80:83], v[192:195], v[184:187], v[80:83]
    v_mul_f32 v67, v67, v11
    v_fma_f32 v74, v74, v18, v26
    v_mfma_f32_16x16x32_bf16 v[80:83], v[200:203], v[188:191], v[80:83]
    v_rcp_f32 v12, v12
    v_mfma_f32_16x16x32_bf16 v[80:83], v[208:211], v[176:179], v[80:83]
    v_exp_f32 v13, v69
    v_mfma_f32_16x16x32_bf16 v[80:83], v[216:219], v[248:251], v[80:83]
    v_mul_f32 v68, v68, v12
    v_cvt_pk_bf16_f32 v65, v66, v67
    v_mfma_f32_16x16x32_bf16 v[80:83], v[224:227], v[252:255], v[80:83]
    v_fma_f32 v13, v13, s44, s44
    v_fma_f32 v75, v75, v19, v27
    v_mfma_f32_16x16x32_bf16 v[80:83], v[232:235], v[240:243], v[80:83]
    v_rcp_f32 v13, v13
    v_mfma_f32_16x16x32_bf16 v[84:87], v[132:135], v[40:43], v[84:87]
    v_exp_f32 v14, v70
    v_mfma_f32_16x16x32_bf16 v[84:87], v[140:143], v[44:47], v[84:87]
    v_mul_f32 v69, v69, v13
    v_fma_f32 v76, v76, v20, v28
    v_mfma_f32_16x16x32_bf16 v[84:87], v[148:151], v[32:35], v[84:87]
    s_waitcnt lgkmcnt(0)
    ds_read_b128 v[40:43], v1 offset:800
    v_mfma_f32_16x16x32_bf16 v[84:87], v[156:159], v[56:59], v[84:87]
    v_fma_f32 v14, v14, s44, s44
    v_cvt_pk_bf16_f32 v66, v68, v69
    v_mfma_f32_16x16x32_bf16 v[84:87], v[164:167], v[60:63], v[84:87]
    v_rcp_f32 v14, v14
    v_mfma_f32_16x16x32_bf16 v[84:87], v[172:175], v[48:51], v[84:87]
    ds_read_b128 v[56:59], v1 offset:864
    v_permlane16_swap_b32 v64, v66
    v_mfma_f32_16x16x32_bf16 v[84:87], v[196:199], v[184:187], v[84:87]
    v_mul_f32 v70, v70, v14
    v_fma_f32 v77, v77, v21, v29
    v_mfma_f32_16x16x32_bf16 v[84:87], v[204:207], v[188:191], v[84:87]
    v_exp_f32 v15, v71
    v_mfma_f32_16x16x32_bf16 v[84:87], v[212:215], v[176:179], v[84:87]
    ds_read_b128 v[184:187], v2 offset:800
    v_fma_f32 v78, v78, v22, v30
    v_mfma_f32_16x16x32_bf16 v[84:87], v[220:223], v[248:251], v[84:87]
    v_fma_f32 v15, v15, s44, s44
    v_fma_f32 v79, v79, v23, v31
    v_mfma_f32_16x16x32_bf16 v[84:87], v[228:231], v[252:255], v[84:87]
    v_rcp_f32 v15, v15
    v_mfma_f32_16x16x32_bf16 v[84:87], v[236:239], v[240:243], v[84:87]
    ds_read_b128 v[248:251], v2 offset:864
    v_fma_f32 v80, v80, v16, v24
    v_mfma_f32_16x16x32_bf16 v[88:91], v[128:131], v[44:47], v[88:91]
    v_mul_f32 v71, v71, v15
    v_fma_f32 v81, v81, v17, v25
    v_mfma_f32_16x16x32_bf16 v[88:91], v[136:139], v[32:35], v[88:91]
    v_cvt_pk_bf16_f32 v67, v70, v71
    v_fma_f32 v82, v82, v18, v26
    v_mfma_f32_16x16x32_bf16 v[88:91], v[144:147], v[36:39], v[88:91]
    v_exp_f32 v8, v72
    v_mfma_f32_16x16x32_bf16 v[88:91], v[152:155], v[60:63], v[88:91]
    v_permlane16_swap_b32 v65, v67
    v_fma_f32 v83, v83, v19, v27
    v_mfma_f32_16x16x32_bf16 v[88:91], v[160:163], v[48:51], v[88:91]
    v_exp_f32 v9, v73
    v_mfma_f32_16x16x32_bf16 v[88:91], v[168:171], v[52:55], v[88:91]
    v_exp_f32 v10, v74
    v_mfma_f32_16x16x32_bf16 v[88:91], v[192:195], v[188:191], v[88:91]
    v_fma_f32 v8, v8, s44, s44
L_stub2:
    s_cbranch_scc1 L_consumer
    v_fma_f32 v9, v9, s44, s44
    v_mfma_f32_16x16x32_bf16 v[88:91], v[200:203], v[176:179], v[88:91]
    buffer_store_dwordx4 v[64:67], v5, s[32:35], 0 offen offset:0 sc0 sc1 nt
    v_fma_f32 v10, v10, s44, s44
    v_mfma_f32_16x16x32_bf16 v[88:91], v[208:211], v[180:183], v[88:91]
    v_rcp_f32 v8, v8
    v_mfma_f32_16x16x32_bf16 v[88:91], v[216:219], v[252:255], v[88:91]
    v_rcp_f32 v9, v9
    v_mfma_f32_16x16x32_bf16 v[88:91], v[224:227], v[240:243], v[88:91]
    v_mul_f32 v72, v72, v8
    v_fma_f32 v84, v84, v20, v28
    v_mfma_f32_16x16x32_bf16 v[88:91], v[232:235], v[244:247], v[88:91]
    v_mul_f32 v73, v73, v9
    v_fma_f32 v85, v85, v21, v29
    v_mfma_f32_16x16x32_bf16 v[92:95], v[132:135], v[44:47], v[92:95]
    v_rcp_f32 v10, v10
    v_mfma_f32_16x16x32_bf16 v[92:95], v[140:143], v[32:35], v[92:95]
    v_exp_f32 v11, v75
    v_mfma_f32_16x16x32_bf16 v[92:95], v[148:151], v[36:39], v[92:95]
    s_waitcnt lgkmcnt(0)
    ds_read_b128 v[44:47], v1 offset:928
    v_mfma_f32_16x16x32_bf16 v[92:95], v[156:159], v[60:63], v[92:95]
    v_mul_f32 v74, v74, v10
    v_fma_f32 v11, v11, s44, s44
    v_mfma_f32_16x16x32_bf16 v[92:95], v[164:167], v[48:51], v[92:95]
    v_rcp_f32 v11, v11
    v_mfma_f32_16x16x32_bf16 v[92:95], v[172:175], v[52:55], v[92:95]
    ds_read_b128 v[60:63], v1 offset:992
    v_cvt_pk_bf16_f32 v72, v72, v73
    v_mfma_f32_16x16x32_bf16 v[92:95], v[196:199], v[188:191], v[92:95]
    v_mul_f32 v75, v75, v11
    v_fma_f32 v86, v86, v22, v30
    v_mfma_f32_16x16x32_bf16 v[92:95], v[204:207], v[176:179], v[92:95]
    v_exp_f32 v12, v76
    v_mfma_f32_16x16x32_bf16 v[92:95], v[212:215], v[180:183], v[92:95]
    ds_read_b128 v[188:191], v2 offset:928
    v_cvt_pk_bf16_f32 v73, v74, v75
    v_mfma_f32_16x16x32_bf16 v[92:95], v[220:223], v[252:255], v[92:95]
    v_fma_f32 v12, v12, s44, s44
    v_fma_f32 v87, v87, v23, v31
    v_mfma_f32_16x16x32_bf16 v[92:95], v[228:231], v[240:243], v[92:95]
    v_rcp_f32 v12, v12
    v_mfma_f32_16x16x32_bf16 v[92:95], v[236:239], v[244:247], v[92:95]
    ds_read_b128 v[252:255], v2 offset:992
    v_fma_f32 v88, v88, v16, v24
    v_mfma_f32_16x16x32_bf16 v[96:99], v[128:131], v[32:35], v[96:99]
    v_mul_f32 v76, v76, v12
    v_fma_f32 v89, v89, v17, v25
    v_mfma_f32_16x16x32_bf16 v[96:99], v[136:139], v[36:39], v[96:99]
    v_exp_f32 v13, v77
    v_mfma_f32_16x16x32_bf16 v[96:99], v[144:147], v[40:43], v[96:99]
    v_exp_f32 v14, v78
    v_mfma_f32_16x16x32_bf16 v[96:99], v[152:155], v[48:51], v[96:99]
    v_fma_f32 v13, v13, s44, s44
    v_fma_f32 v90, v90, v18, v26
    v_mfma_f32_16x16x32_bf16 v[96:99], v[160:163], v[52:55], v[96:99]
    v_rcp_f32 v13, v13
    v_mfma_f32_16x16x32_bf16 v[96:99], v[168:171], v[56:59], v[96:99]
    v_fma_f32 v14, v14, s44, s44
    v_fma_f32 v91, v91, v19, v27
    v_mfma_f32_16x16x32_bf16 v[96:99], v[192:195], v[176:179], v[96:99]
    v_rcp_f32 v14, v14
    v_mfma_f32_16x16x32_bf16 v[96:99], v[200:203], v[180:183], v[96:99]
    v_mul_f32 v77, v77, v13
    v_fma_f32 v92, v92, v20, v28
    v_mfma_f32_16x16x32_bf16 v[96:99], v[208:211], v[184:187], v[96:99]
    v_mul_f32 v78, v78, v14
    v_cvt_pk_bf16_f32 v74, v76, v77
    v_mfma_f32_16x16x32_bf16 v[96:99], v[216:219], v[240:243], v[96:99]
    v_exp_f32 v15, v79
    v_mfma_f32_16x16x32_bf16 v[96:99], v[224:227], v[244:247], v[96:99]
    v_permlane16_swap_b32 v72, v74
    v_fma_f32 v93, v93, v21, v29
    v_mfma_f32_16x16x32_bf16 v[96:99], v[232:235], v[248:251], v[96:99]
    v_fma_f32 v15, v15, s44, s44
    v_fma_f32 v94, v94, v22, v30
    v_mfma_f32_16x16x32_bf16 v[100:103], v[132:135], v[32:35], v[100:103]
    v_rcp_f32 v15, v15
    v_mfma_f32_16x16x32_bf16 v[100:103], v[140:143], v[36:39], v[100:103]
    v_exp_f32 v8, v80
    v_mfma_f32_16x16x32_bf16 v[100:103], v[148:151], v[40:43], v[100:103]
    s_waitcnt lgkmcnt(0)
    ds_read_b128 v[32:35], v1 offset:1056
    v_mfma_f32_16x16x32_bf16 v[100:103], v[156:159], v[48:51], v[100:103]
    v_mul_f32 v79, v79, v15
    v_fma_f32 v8, v8, s44, s44
    v_mfma_f32_16x16x32_bf16 v[100:103], v[164:167], v[52:55], v[100:103]
    v_cvt_pk_bf16_f32 v75, v78, v79
    v_fma_f32 v95, v95, v23, v31
    v_mfma_f32_16x16x32_bf16 v[100:103], v[172:175], v[56:59], v[100:103]
    ds_read_b128 v[48:51], v1 offset:1120
    v_mfma_f32_16x16x32_bf16 v[100:103], v[196:199], v[176:179], v[100:103]
    v_rcp_f32 v8, v8
    v_mfma_f32_16x16x32_bf16 v[100:103], v[204:207], v[180:183], v[100:103]
    v_permlane16_swap_b32 v73, v75
    v_fma_f32 v96, v96, v16, v24
    v_mfma_f32_16x16x32_bf16 v[100:103], v[212:215], v[184:187], v[100:103]
    ds_read_b128 v[176:179], v2 offset:1056
    v_mul_f32 v80, v80, v8
    v_mfma_f32_16x16x32_bf16 v[100:103], v[220:223], v[240:243], v[100:103]
    v_exp_f32 v9, v81
    v_mfma_f32_16x16x32_bf16 v[100:103], v[228:231], v[244:247], v[100:103]
    v_exp_f32 v10, v82
    v_mfma_f32_16x16x32_bf16 v[100:103], v[236:239], v[248:251], v[100:103]
    ds_read_b128 v[240:243], v2 offset:1120
    buffer_store_dwordx4 v[72:75], v5, s[32:35], 0 offen offset:896 sc0 sc1 nt
    v_mfma_f32_16x16x32_bf16 v[104:107], v[128:131], v[36:39], v[104:107]
    v_fma_f32 v9, v9, s44, s44
    v_fma_f32 v10, v10, s44, s44
    v_mfma_f32_16x16x32_bf16 v[104:107], v[136:139], v[40:43], v[104:107]
    v_rcp_f32 v9, v9
    v_mfma_f32_16x16x32_bf16 v[104:107], v[144:147], v[44:47], v[104:107]
    v_rcp_f32 v10, v10
    v_mfma_f32_16x16x32_bf16 v[104:107], v[152:155], v[52:55], v[104:107]
    v_mul_f32 v81, v81, v9
    v_fma_f32 v97, v97, v17, v25
    v_mfma_f32_16x16x32_bf16 v[104:107], v[160:163], v[56:59], v[104:107]
    v_mul_f32 v82, v82, v10
    v_cvt_pk_bf16_f32 v80, v80, v81
    v_mfma_f32_16x16x32_bf16 v[104:107], v[168:171], v[60:63], v[104:107]
    v_exp_f32 v11, v83
    v_mfma_f32_16x16x32_bf16 v[104:107], v[192:195], v[180:183], v[104:107]
    v_exp_f32 v12, v84
    v_mfma_f32_16x16x32_bf16 v[104:107], v[200:203], v[184:187], v[104:107]
    v_fma_f32 v11, v11, s44, s44
    v_fma_f32 v98, v98, v18, v26
    v_mfma_f32_16x16x32_bf16 v[104:107], v[208:211], v[188:191], v[104:107]
    v_rcp_f32 v11, v11
    v_mfma_f32_16x16x32_bf16 v[104:107], v[216:219], v[244:247], v[104:107]
    v_fma_f32 v12, v12, s44, s44
    v_fma_f32 v99, v99, v19, v27
    v_mfma_f32_16x16x32_bf16 v[104:107], v[224:227], v[248:251], v[104:107]
    v_mul_f32 v83, v83, v11
    v_fma_f32 v100, v100, v20, v28
    v_mfma_f32_16x16x32_bf16 v[104:107], v[232:235], v[252:255], v[104:107]
    v_rcp_f32 v12, v12
    v_mfma_f32_16x16x32_bf16 v[108:111], v[132:135], v[36:39], v[108:111]
    v_exp_f32 v13, v85
    v_mfma_f32_16x16x32_bf16 v[108:111], v[140:143], v[40:43], v[108:111]
    v_mul_f32 v84, v84, v12
    v_cvt_pk_bf16_f32 v81, v82, v83
    v_mfma_f32_16x16x32_bf16 v[108:111], v[148:151], v[44:47], v[108:111]
    s_waitcnt lgkmcnt(0)
    ds_read_b128 v[36:39], v1 offset:1216
    v_mfma_f32_16x16x32_bf16 v[108:111], v[156:159], v[52:55], v[108:111]
    v_fma_f32 v13, v13, s44, s44
    v_fma_f32 v101, v101, v21, v29
    v_mfma_f32_16x16x32_bf16 v[108:111], v[164:167], v[56:59], v[108:111]
    v_rcp_f32 v13, v13
    v_mfma_f32_16x16x32_bf16 v[108:111], v[172:175], v[60:63], v[108:111]
    ds_read_b128 v[52:55], v1 offset:1280
    v_fma_f32 v102, v102, v22, v30
    v_mfma_f32_16x16x32_bf16 v[108:111], v[196:199], v[180:183], v[108:111]
    v_mul_f32 v85, v85, v13
    v_fma_f32 v103, v103, v23, v31
    v_mfma_f32_16x16x32_bf16 v[108:111], v[204:207], v[184:187], v[108:111]
    v_exp_f32 v14, v86
    v_mfma_f32_16x16x32_bf16 v[108:111], v[212:215], v[188:191], v[108:111]
    ds_read_b128 v[180:183], v2 offset:1216
    v_cvt_pk_bf16_f32 v82, v84, v85
    v_mfma_f32_16x16x32_bf16 v[108:111], v[220:223], v[244:247], v[108:111]
    v_exp_f32 v15, v87
    v_mfma_f32_16x16x32_bf16 v[108:111], v[228:231], v[248:251], v[108:111]
    v_fma_f32 v14, v14, s44, s44
    v_permlane16_swap_b32 v80, v82
    v_mfma_f32_16x16x32_bf16 v[108:111], v[236:239], v[252:255], v[108:111]
    ds_read_b128 v[244:247], v2 offset:1280
    v_fma_f32 v15, v15, s44, s44
    v_mfma_f32_16x16x32_bf16 v[112:115], v[128:131], v[40:43], v[112:115]
    v_rcp_f32 v14, v14
    v_mfma_f32_16x16x32_bf16 v[112:115], v[136:139], v[44:47], v[112:115]
    v_rcp_f32 v15, v15
    v_mfma_f32_16x16x32_bf16 v[112:115], v[144:147], v[32:35], v[112:115]
    v_exp_f32 v8, v88
    v_mfma_f32_16x16x32_bf16 v[112:115], v[152:155], v[56:59], v[112:115]
    v_mul_f32 v86, v86, v14
    v_mul_f32 v87, v87, v15
    v_mfma_f32_16x16x32_bf16 v[112:115], v[160:163], v[60:63], v[112:115]
    v_cvt_pk_bf16_f32 v83, v86, v87
    v_fma_f32 v8, v8, s44, s44
    v_mfma_f32_16x16x32_bf16 v[112:115], v[168:171], v[48:51], v[112:115]
    v_rcp_f32 v8, v8
    v_mfma_f32_16x16x32_bf16 v[112:115], v[192:195], v[184:187], v[112:115]
    v_exp_f32 v9, v89
    v_mfma_f32_16x16x32_bf16 v[112:115], v[200:203], v[188:191], v[112:115]
    v_permlane16_swap_b32 v81, v83
    v_mul_f32 v88, v88, v8
    v_mfma_f32_16x16x32_bf16 v[112:115], v[208:211], v[176:179], v[112:115]
    v_exp_f32 v10, v90
    v_mfma_f32_16x16x32_bf16 v[112:115], v[216:219], v[248:251], v[112:115]
    v_exp_f32 v11, v91
    v_mfma_f32_16x16x32_bf16 v[112:115], v[224:227], v[252:255], v[112:115]
    v_fma_f32 v9, v9, s44, s44
    v_fma_f32 v10, v10, s44, s44
    v_mfma_f32_16x16x32_bf16 v[112:115], v[232:235], v[240:243], v[112:115]
    buffer_store_dwordx4 v[80:83], v5, s[32:35], 0 offen offset:1792 sc0 sc1 nt
    v_fma_f32 v11, v11, s44, s44
    v_mfma_f32_16x16x32_bf16 v[116:119], v[132:135], v[40:43], v[116:119]
    v_rcp_f32 v9, v9
    v_mfma_f32_16x16x32_bf16 v[116:119], v[140:143], v[44:47], v[116:119]
    v_rcp_f32 v10, v10
    v_mfma_f32_16x16x32_bf16 v[116:119], v[148:151], v[32:35], v[116:119]
    s_waitcnt lgkmcnt(0)
    v_mul_f32 v89, v89, v9
    v_mfma_f32_16x16x32_bf16 v[116:119], v[156:159], v[56:59], v[116:119]
    v_mul_f32 v90, v90, v10
    v_cvt_pk_bf16_f32 v88, v88, v89
    v_mfma_f32_16x16x32_bf16 v[116:119], v[164:167], v[60:63], v[116:119]
    v_rcp_f32 v11, v11
    v_mfma_f32_16x16x32_bf16 v[116:119], v[172:175], v[48:51], v[116:119]
    v_exp_f32 v12, v92
    v_mfma_f32_16x16x32_bf16 v[116:119], v[196:199], v[184:187], v[116:119]
    v_exp_f32 v13, v93
    v_mfma_f32_16x16x32_bf16 v[116:119], v[204:207], v[188:191], v[116:119]
    v_mul_f32 v91, v91, v11
    v_fma_f32 v12, v12, s44, s44
    v_mfma_f32_16x16x32_bf16 v[116:119], v[212:215], v[176:179], v[116:119]
    v_rcp_f32 v12, v12
    v_mfma_f32_16x16x32_bf16 v[116:119], v[220:223], v[248:251], v[116:119]
    v_fma_f32 v13, v13, s44, s44
    v_cvt_pk_bf16_f32 v89, v90, v91
    v_mfma_f32_16x16x32_bf16 v[116:119], v[228:231], v[252:255], v[116:119]
    v_rcp_f32 v13, v13
    v_mfma_f32_16x16x32_bf16 v[116:119], v[236:239], v[240:243], v[116:119]
    v_exp_f32 v14, v94
    v_mfma_f32_16x16x32_bf16 v[120:123], v[128:131], v[44:47], v[120:123]
    v_mul_f32 v92, v92, v12
    v_mul_f32 v93, v93, v13
    v_mfma_f32_16x16x32_bf16 v[120:123], v[136:139], v[32:35], v[120:123]
    v_fma_f32 v14, v14, s44, s44
    v_cvt_pk_bf16_f32 v90, v92, v93
    v_mfma_f32_16x16x32_bf16 v[120:123], v[144:147], v[36:39], v[120:123]
    v_rcp_f32 v14, v14
    v_mfma_f32_16x16x32_bf16 v[120:123], v[152:155], v[60:63], v[120:123]
    v_exp_f32 v15, v95
    v_mfma_f32_16x16x32_bf16 v[120:123], v[160:163], v[48:51], v[120:123]
    v_mul_f32 v94, v94, v14
    v_permlane16_swap_b32 v88, v90
    v_mfma_f32_16x16x32_bf16 v[120:123], v[168:171], v[52:55], v[120:123]
    v_exp_f32 v8, v96
    v_mfma_f32_16x16x32_bf16 v[120:123], v[192:195], v[188:191], v[120:123]
    v_exp_f32 v9, v97
    v_mfma_f32_16x16x32_bf16 v[120:123], v[200:203], v[176:179], v[120:123]
    v_fma_f32 v15, v15, s44, s44
    v_fma_f32 v8, v8, s44, s44
    v_mfma_f32_16x16x32_bf16 v[120:123], v[208:211], v[180:183], v[120:123]
    v_rcp_f32 v15, v15
    v_mfma_f32_16x16x32_bf16 v[120:123], v[216:219], v[252:255], v[120:123]
    v_rcp_f32 v8, v8
    v_mfma_f32_16x16x32_bf16 v[120:123], v[224:227], v[240:243], v[120:123]
    v_mul_f32 v95, v95, v15
    v_fma_f32 v9, v9, s44, s44
    v_mfma_f32_16x16x32_bf16 v[120:123], v[232:235], v[244:247], v[120:123]
    v_cvt_pk_bf16_f32 v91, v94, v95
    v_mul_f32 v96, v96, v8
    v_mfma_f32_16x16x32_bf16 v[124:127], v[132:135], v[44:47], v[124:127]
    v_rcp_f32 v9, v9
    v_mfma_f32_16x16x32_bf16 v[124:127], v[140:143], v[32:35], v[124:127]
    v_exp_f32 v10, v98
    v_mfma_f32_16x16x32_bf16 v[124:127], v[148:151], v[36:39], v[124:127]
    v_permlane16_swap_b32 v89, v91
    v_mul_f32 v97, v97, v9
    v_mfma_f32_16x16x32_bf16 v[124:127], v[156:159], v[60:63], v[124:127]
    v_fma_f32 v10, v10, s44, s44
    v_cvt_pk_bf16_f32 v96, v96, v97
    v_mfma_f32_16x16x32_bf16 v[124:127], v[164:167], v[48:51], v[124:127]
    v_rcp_f32 v10, v10
    v_mfma_f32_16x16x32_bf16 v[124:127], v[172:175], v[52:55], v[124:127]
    v_exp_f32 v11, v99
    v_mfma_f32_16x16x32_bf16 v[124:127], v[196:199], v[188:191], v[124:127]
    buffer_store_dwordx4 v[88:91], v5, s[32:35], 0 offen offset:2688 sc0 sc1 nt
    v_mul_f32 v98, v98, v10
    v_mfma_f32_16x16x32_bf16 v[124:127], v[204:207], v[176:179], v[124:127]
    v_exp_f32 v12, v100
    v_mfma_f32_16x16x32_bf16 v[124:127], v[212:215], v[180:183], v[124:127]
    v_exp_f32 v13, v101
    v_mfma_f32_16x16x32_bf16 v[124:127], v[220:223], v[252:255], v[124:127]
    v_fma_f32 v11, v11, s44, s44
    v_fma_f32 v12, v12, s44, s44
    v_mfma_f32_16x16x32_bf16 v[124:127], v[228:231], v[240:243], v[124:127]
    v_rcp_f32 v11, v11
    v_mfma_f32_16x16x32_bf16 v[124:127], v[236:239], v[244:247], v[124:127]
    v_rcp_f32 v12, v12
    v_exp_f32 v14, v102
    v_fma_f32 v13, v13, s44, s44
    v_exp_f32 v15, v103
    v_mul_f32 v99, v99, v11
    v_mul_f32 v100, v100, v12
    v_rcp_f32 v13, v13
    v_fma_f32 v14, v14, s44, s44
    v_fma_f32 v15, v15, s44, s44
    v_cvt_pk_bf16_f32 v97, v98, v99
    v_pk_fma_f32 v[104:105], v[104:105], v[16:17], v[24:25]
    v_mul_f32 v101, v101, v13
    v_rcp_f32 v14, v14
    v_rcp_f32 v15, v15
    v_exp_f32 v128, v104
    v_cvt_pk_bf16_f32 v98, v100, v101
    v_exp_f32 v129, v105
    v_mul_f32 v102, v102, v14
    v_mul_f32 v103, v103, v15
    v_pk_fma_f32 v[106:107], v[106:107], v[18:19], v[26:27]
    v_permlane16_swap_b32 v96, v98
    v_pk_fma_f32 v[128:129], v[128:129], s[44:45], s[44:45]
    v_cvt_pk_bf16_f32 v99, v102, v103
    v_exp_f32 v130, v106
    v_exp_f32 v131, v107
    v_rcp_f32 v128, v128
    v_rcp_f32 v129, v129
    v_permlane16_swap_b32 v97, v99
    v_pk_fma_f32 v[130:131], v[130:131], s[44:45], s[44:45]
    v_pk_fma_f32 v[108:109], v[108:109], v[20:21], v[28:29]
    v_pk_mul_f32 v[104:105], v[104:105], v[128:129]
    v_pk_fma_f32 v[110:111], v[110:111], v[22:23], v[30:31]
    v_rcp_f32 v130, v130
    v_rcp_f32 v131, v131
    buffer_store_dwordx4 v[96:99], v5, s[32:35], s46 offen offset:0 sc0 sc1 nt
    v_exp_f32 v132, v108
    v_exp_f32 v133, v109
    v_pk_mul_f32 v[106:107], v[106:107], v[130:131]
    v_exp_f32 v134, v110
    v_exp_f32 v135, v111
    v_pk_fma_f32 v[132:133], v[132:133], s[44:45], s[44:45]
    v_cvt_pk_bf16_f32 v104, v104, v105
    v_cvt_pk_bf16_f32 v105, v106, v107
    v_pk_fma_f32 v[134:135], v[134:135], s[44:45], s[44:45]
    v_rcp_f32 v132, v132
    v_rcp_f32 v133, v133
    v_pk_fma_f32 v[112:113], v[112:113], v[16:17], v[24:25]
    v_rcp_f32 v134, v134
    v_rcp_f32 v135, v135
    v_pk_mul_f32 v[108:109], v[108:109], v[132:133]
    v_exp_f32 v136, v112
    v_exp_f32 v137, v113
    v_pk_mul_f32 v[110:111], v[110:111], v[134:135]
    v_cvt_pk_bf16_f32 v106, v108, v109
    v_pk_fma_f32 v[114:115], v[114:115], v[18:19], v[26:27]
    v_pk_fma_f32 v[136:137], v[136:137], s[44:45], s[44:45]
    v_cvt_pk_bf16_f32 v107, v110, v111
    v_pk_fma_f32 v[116:117], v[116:117], v[20:21], v[28:29]
    v_permlane16_swap_b32 v104, v106
    v_rcp_f32 v136, v136
    v_rcp_f32 v137, v137
    v_permlane16_swap_b32 v105, v107
    v_exp_f32 v138, v114
    v_exp_f32 v139, v115
    v_pk_mul_f32 v[112:113], v[112:113], v[136:137]
    v_exp_f32 v140, v116
    v_exp_f32 v141, v117
    v_pk_fma_f32 v[138:139], v[138:139], s[44:45], s[44:45]
    buffer_store_dwordx4 v[104:107], v5, s[32:35], s46 offen offset:896 sc0 sc1 nt
    v_pk_fma_f32 v[118:119], v[118:119], v[22:23], v[30:31]
    v_pk_fma_f32 v[140:141], v[140:141], s[44:45], s[44:45]
    v_rcp_f32 v138, v138
    v_rcp_f32 v139, v139
    v_exp_f32 v142, v118
    v_rcp_f32 v140, v140
    v_rcp_f32 v141, v141
    v_pk_mul_f32 v[114:115], v[114:115], v[138:139]
    v_exp_f32 v143, v119
    v_cvt_pk_bf16_f32 v112, v112, v113
    v_pk_mul_f32 v[116:117], v[116:117], v[140:141]
    v_cvt_pk_bf16_f32 v113, v114, v115
    v_pk_fma_f32 v[142:143], v[142:143], s[44:45], s[44:45]
    v_pk_fma_f32 v[120:121], v[120:121], v[16:17], v[24:25]
    v_cvt_pk_bf16_f32 v114, v116, v117
    v_pk_fma_f32 v[122:123], v[122:123], v[18:19], v[26:27]
    v_rcp_f32 v142, v142
    v_rcp_f32 v143, v143
    v_exp_f32 v144, v120
    v_permlane16_swap_b32 v112, v114
    v_exp_f32 v145, v121
    v_pk_mul_f32 v[118:119], v[118:119], v[142:143]
    v_exp_f32 v146, v122
    v_exp_f32 v147, v123
    v_pk_fma_f32 v[144:145], v[144:145], s[44:45], s[44:45]
    v_cvt_pk_bf16_f32 v115, v118, v119
    v_pk_fma_f32 v[124:125], v[124:125], v[20:21], v[28:29]
    v_pk_fma_f32 v[146:147], v[146:147], s[44:45], s[44:45]
    v_rcp_f32 v144, v144
    v_rcp_f32 v145, v145
    v_permlane16_swap_b32 v113, v115
    v_rcp_f32 v146, v146
    v_rcp_f32 v147, v147
    v_pk_mul_f32 v[120:121], v[120:121], v[144:145]
    v_exp_f32 v148, v124
    v_exp_f32 v149, v125
    v_pk_mul_f32 v[122:123], v[122:123], v[146:147]
    buffer_store_dwordx4 v[112:115], v5, s[32:35], s46 offen offset:1792 sc0 sc1 nt
    v_pk_fma_f32 v[126:127], v[126:127], v[22:23], v[30:31]
    v_pk_fma_f32 v[148:149], v[148:149], s[44:45], s[44:45]
    v_cvt_pk_bf16_f32 v120, v120, v121
    v_cvt_pk_bf16_f32 v121, v122, v123
    v_exp_f32 v150, v126
    v_rcp_f32 v148, v148
    v_rcp_f32 v149, v149
    v_exp_f32 v151, v127
    v_pk_mul_f32 v[124:125], v[124:125], v[148:149]
    v_pk_fma_f32 v[150:151], v[150:151], s[44:45], s[44:45]
    v_cvt_pk_bf16_f32 v122, v124, v125
    v_rcp_f32 v150, v150
    v_rcp_f32 v151, v151
    v_permlane16_swap_b32 v120, v122
    v_pk_mul_f32 v[126:127], v[126:127], v[150:151]
    s_nop 0
    v_cvt_pk_bf16_f32 v123, v126, v127
    s_nop 0
    s_nop 0
    v_permlane16_swap_b32 v121, v123
    buffer_store_dwordx4 v[120:123], v5, s[32:35], s46 offen offset:2688 sc0 sc1 nt
    s_endpgm
L_loader3:
    s_endpgm
L_end:
    s_endpgm
.section .rodata,"a"
.p2align 6
.amdhsa_kernel standalone__batchnorm__prompt_kernel
  .amdhsa_next_free_vgpr 256
  .amdhsa_next_free_sgpr 102
  .amdhsa_accum_offset 256
  .amdhsa_group_segment_fixed_size 0
  .amdhsa_kernarg_size 72
  .amdhsa_user_sgpr_count 2
  .amdhsa_user_sgpr_kernarg_segment_ptr 1
  .amdhsa_system_sgpr_workgroup_id_x 1
.end_amdhsa_kernel
```
